```python
import torch

def _softmax(x, axis=-1):
    return torch.softmax(x, dim=axis)
def _gelu(x):
    return torch.nn.functional.gelu(x, approximate="tanh")
def _silu(x):
    return torch.nn.functional.silu(x)
def _sigmoid(x):
    return torch.sigmoid(x)
def _layernorm(x, axis=-1, eps=1e-5):
    m = x.mean(dim=axis, keepdim=True)
    v = x.var(dim=axis, keepdim=True, unbiased=False)
    return (x - m) / torch.sqrt(v + eps)
def _scatter_add(tgt, idx, src, axis=0):
    return tgt.clone().index_add_(axis, idx, src)
def _segment_sum(src, seg, n):
    out = torch.zeros((n,) + src.shape[1:], dtype=src.dtype)
    return out.index_add_(0, seg, src)
def _pad(x, pw):
    flat = tuple(v for pair in reversed(pw) for v in pair)
    return torch.nn.functional.pad(x, flat)

kernel_name = 'sequential_preLN__gqa_block_cached__geglu_ffn__decode'

def setup_inputs():

    _w = (lambda a: (lambda t: t.to(torch.bfloat16) if t.is_floating_point() else t)(torch.as_tensor(a)))
    def _A_setup():
        B, Sq, D = 4, 1, 512
        Hq, Hkv, Sk, Dh = 32, 32, 8192, 128
        assert Hq % Hkv == 0, (Hq, Hkv)
        return {
            "x": _w((lambda *s: torch.randn(*s, dtype=torch.bfloat16) * 0.05)(B, Sq, D)),
            "k_cache": _w((lambda *s: torch.randn(*s, dtype=torch.bfloat16) * 3.2)(B, Hkv, Sk, Dh)),
            "v_cache": _w((lambda *s: torch.randn(*s, dtype=torch.bfloat16) * 0.4)(B, Hkv, Sk, Dh)),
            "wq": _w((lambda *s: torch.randn(*s, dtype=torch.bfloat16) * 3.2)(D, Hq * Dh) * (D ** -0.5)),
            "wo": _w((lambda *s: torch.randn(*s, dtype=torch.bfloat16) * 0.4)(Hq * Dh, D) * ((Hq * Dh) ** -0.5)),
        }
    _A_in = _A_setup()

    def _B_setup():
        B, S, D, F = 4, 1, 512, 1376
        return {
            "x": _w((lambda *s: torch.randn(*s, dtype=torch.bfloat16) * 0.05)(B, S, D)),
            "w_gate": _w((lambda *s: torch.randn(*s, dtype=torch.bfloat16) * 0.05)(D, F)),
            "w_up": _w((lambda *s: torch.randn(*s, dtype=torch.bfloat16) * 0.05)(D, F)),
            "w_down": _w((lambda *s: torch.randn(*s, dtype=torch.bfloat16) * 0.05)(F, D)),
        }
    _B_in = _B_setup()

    return {
        "A_x": _A_in["x"],
        "A_k_cache": _A_in["k_cache"],
        "A_v_cache": _A_in["v_cache"],
        "A_wq": _A_in["wq"],
        "A_wo": _A_in["wo"],
        "B_x": _B_in["x"],
        "B_w_gate": _B_in["w_gate"],
        "B_w_up": _B_in["w_up"],
        "B_w_down": _B_in["w_down"],
    }

def reference(A_x, A_k_cache, A_v_cache, A_wq, A_wo, B_x, B_w_gate, B_w_up, B_w_down):
    def _A_ref(x, k_cache, v_cache, wq, wo):
        B, Sq, D = x.shape
        Hq, Dh = 32, 128
        Hkv = k_cache.shape[1]
        rep = Hq // Hkv
        q = (lambda x, *d: x.permute(*d))((x @ wq).reshape(B, Sq, Hq, Dh), 0, 2, 1, 3)
        k = (lambda x, n, axis: torch.repeat_interleave(x, n, dim=axis))(k_cache, rep, axis=1)
        v = (lambda x, n, axis: torch.repeat_interleave(x, n, dim=axis))(v_cache, rep, axis=1)
        scores = torch.einsum("bhqd,bhkd->bhqk", q, k) * (Dh ** -0.5)
        p = _softmax(scores, axis=-1)
        o = torch.einsum("bhqk,bhkd->bhqd", p, v)
        return (lambda x, *d: x.permute(*d))(o, 0, 2, 1, 3).reshape(B, Sq, Hq * Dh) @ wo

    def _B_ref(x, w_gate, w_up, w_down):
        return (_gelu(x @ w_gate) * (x @ w_up)) @ w_down

    x = A_x
    h = x + _A_ref(_layernorm(x, axis=-1), A_k_cache, A_v_cache, A_wq, A_wo)
    h2 = h + _B_ref(_layernorm(h, axis=-1), B_w_gate, B_w_up, B_w_down)
    return h2
```

```asm
; @launch grid=(256,1,1) block=(512,1,1) lds=147456
.amdgcn_target "amdgcn-amd-amdhsa--gfx950"
.text
.globl sequential_preLN__gqa_block_cached__geglu_ffn__decode_kernel
.p2align 8
.type sequential_preLN__gqa_block_cached__geglu_ffn__decode_kernel,@function
sequential_preLN__gqa_block_cached__geglu_ffn__decode_kernel:
  s_cmp_ge_u32 s2, 256
  s_cbranch_scc1 L_exit
  s_load_dwordx16 s[4:19], s[0:1], 0
  s_load_dwordx8 s[20:27], s[0:1], 64
  s_getpc_b64 s[66:67]
L_pc:
  v_lshlrev_b32 v2, 5, v0
  v_cmp_gt_u32 vcc, L_codeend-L_pc-32, v2
  s_and_saveexec_b64 s[68:69], vcc
  s_cbranch_execz L_nopfc
  global_load_dwordx4 v[120:123], v2, s[66:67]
  global_load_dwordx4 v[124:127], v2, s[66:67] offset:16
L_nopfc:
  s_mov_b64 exec, s[68:69]
  v_lshrrev_b32 v1, 6, v0
  v_and_b32 v0, 63, v0
  v_readfirstlane_b32 s3, v1
  s_and_b32 s28, s2, 7
  s_lshr_b32 s29, s28, 1
  s_and_b32 s30, s29, 1
  s_xor_b32 s29, s29, s28
  s_and_b32 s29, s29, 1
  s_lshr_b32 s28, s28, 2
  s_lshl_b32 s28, s28, 1
  s_add_u32 s28, s28, s29
  s_lshr_b32 s31, s2, 3
  s_and_b32 s29, s31, 7
  s_lshl_b32 s29, s29, 2
  s_add_u32 s28, s28, s29
  s_lshr_b32 s29, s31, 3
  s_lshl_b32 s31, s29, 5
  s_add_u32 s31, s31, s28
  s_cmp_ge_u32 s3, 4
  s_cbranch_scc1 L_tail
  v_lshrrev_b32 v68, 2, v0
  v_and_b32 v68, 3, v68
  v_lshlrev_b32 v8, 8, v68
  v_lshrrev_b32 v68, 4, v0
  v_lshlrev_b32 v68, 6, v68
  v_add_u32 v8, v8, v68
  v_and_b32 v68, 3, v0
  v_lshlrev_b32 v68, 4, v68
  v_add_u32 v8, v8, v68
  v_lshlrev_b32 v12, 4, v0
  s_lshl_b32 s53, s30, 2
  s_add_u32 s53, s53, s3
  s_lshr_b32 s44, s53, 2
  s_lshl_b32 s44, s44, 16
  s_and_b32 s58, s53, 3
  s_lshl_b32 s58, s58, 10
  s_add_u32 s44, s44, s58
  s_add_u32 s45, s44, 16384
  s_add_u32 s46, s44, 32768
  s_add_u32 s47, s44, 49152
  v_add_u32 v9, 4096, v8
  v_add_u32 v13, 4096, v12
  v_add_u32 v10, 8192, v8
  v_add_u32 v14, 8192, v12
  v_add_u32 v11, 12288, v8
  v_add_u32 v15, 12288, v12
  s_lshl_b32 s58, s31, 21
  s_waitcnt lgkmcnt(0)
  s_add_u32 s32, s6, s58
  s_addc_u32 s33, s7, 0
  s_mov_b32 s34, 2097152
  s_mov_b32 s35, 0x20000
  s_add_u32 s36, s8, s58
  s_addc_u32 s37, s9, 0
  s_mov_b32 s38, 2097152
  s_mov_b32 s39, 0x20000
  buffer_load_dwordx4 a[0:3], v8, s[32:35], s44 offen nt
  buffer_load_dwordx4 a[4:7], v9, s[32:35], s44 offen nt
  buffer_load_dwordx4 a[8:11], v10, s[32:35], s44 offen nt
  buffer_load_dwordx4 a[12:15], v11, s[32:35], s44 offen nt
  buffer_load_dwordx4 a[16:19], v8, s[32:35], s45 offen nt
  s_waitcnt vmcnt(4)
  buffer_load_dwordx4 a[20:23], v9, s[32:35], s45 offen nt
  s_waitcnt vmcnt(4)
  buffer_load_dwordx4 a[24:27], v10, s[32:35], s45 offen nt
  s_waitcnt vmcnt(4)
  buffer_load_dwordx4 a[28:31], v11, s[32:35], s45 offen nt
  s_waitcnt vmcnt(4)
  buffer_load_dwordx4 a[32:35], v8, s[32:35], s46 offen nt
  s_waitcnt vmcnt(4)
  buffer_load_dwordx4 a[36:39], v9, s[32:35], s46 offen nt
  buffer_load_dword v110, v12, s[36:39], s44 offen nt
  s_waitcnt vmcnt(4)
  buffer_load_dwordx4 a[40:43], v10, s[32:35], s46 offen nt
  s_waitcnt vmcnt(4)
  buffer_load_dwordx4 a[44:47], v11, s[32:35], s46 offen nt
  s_waitcnt vmcnt(4)
  buffer_load_dwordx4 a[48:51], v8, s[32:35], s47 offen nt
  s_waitcnt vmcnt(4)
  buffer_load_dwordx4 a[52:55], v9, s[32:35], s47 offen nt
  s_waitcnt vmcnt(4)
  buffer_load_dwordx4 a[56:59], v10, s[32:35], s47 offen nt
  s_waitcnt vmcnt(4)
  buffer_load_dwordx4 a[60:63], v11, s[32:35], s47 offen nt
  s_load_dword s60, s[26:27], 0xff000
  s_cmp_ge_u32 s2, 43
  s_cselect_b32 s58, 43, 0
  s_sub_u32 s65, s2, s58
  s_cmp_ge_u32 s2, 86
  s_cselect_b32 s58, 43, 0
  s_sub_u32 s65, s65, s58
  s_lshl_b32 s64, s65, 7
  s_add_u32 s64, s64, 1015808
  s_mov_b32 s40, s26
  s_mov_b32 s41, s27
  s_mov_b32 s42, 2883584
  s_mov_b32 s43, 0x20000
  v_and_b32 v68, 15, v0
  v_and_b32 v69, 1, v0
  v_lshlrev_b32 v69, 4, v69
  v_mov_b32 v70, 0xffff
  v_lshlrev_b32 v69, v69, v70
  v_lshrrev_b32 v68, 1, v68
  v_cmp_eq_u32 vcc, 0, v68
  s_nop 1
  v_cndmask_b32 v60, 0, v69, vcc
  v_cmp_eq_u32 vcc, 1, v68
  s_nop 1
  v_cndmask_b32 v61, 0, v69, vcc
  v_cmp_eq_u32 vcc, 2, v68
  s_nop 1
  v_cndmask_b32 v62, 0, v69, vcc
  v_cmp_eq_u32 vcc, 3, v68
  s_nop 1
  v_cndmask_b32 v63, 0, v69, vcc
  v_and_b32 v68, 1, v0
  v_cmp_eq_u32 s[54:55], 1, v68
  v_and_b32 v68, 2, v0
  v_cmp_eq_u32 s[56:57], 2, v68
  v_mov_b32 v64, 0xff7fffff
  v_mov_b32 v65, 0
  v_mov_b32 v5, 0
  v_mov_b32 v48, 0
  v_mov_b32 v49, 0
  v_mov_b32 v50, 0
  v_mov_b32 v51, 0
  v_lshrrev_b32 v68, 4, v0
  v_lshlrev_b32 v68, 2, v68
  v_and_b32 v69, 3, v0
  v_add_u32 v68, v68, v69
  v_lshlrev_b32 v68, 5, v68
  v_lshrrev_b32 v69, 2, v0
  v_and_b32 v69, 3, v69
  s_mov_b32 s52, 0
  s_waitcnt vmcnt(4)
  buffer_load_dwordx4 a[64:67], v12, s[36:39], s44 offen nt
  s_waitcnt vmcnt(4)
  buffer_load_dwordx4 a[68:71], v13, s[36:39], s44 offen nt
  s_waitcnt vmcnt(4)
  buffer_load_dwordx4 a[72:75], v14, s[36:39], s44 offen nt
  s_waitcnt vmcnt(4)
  buffer_load_dwordx4 a[76:79], v15, s[36:39], s44 offen nt
  s_waitcnt vmcnt(4)
  buffer_load_dwordx4 a[80:83], v12, s[36:39], s45 offen nt
  s_waitcnt vmcnt(4)
  buffer_load_dwordx4 a[84:87], v13, s[36:39], s45 offen nt
  s_waitcnt vmcnt(4)
  buffer_load_dwordx4 a[88:91], v14, s[36:39], s45 offen nt
  s_waitcnt vmcnt(4)
  buffer_load_dwordx4 a[92:95], v15, s[36:39], s45 offen nt
  s_waitcnt vmcnt(4)
  buffer_load_dwordx4 a[96:99], v12, s[36:39], s46 offen nt
  s_waitcnt vmcnt(4)
  buffer_load_dwordx4 a[100:103], v13, s[36:39], s46 offen nt
  s_waitcnt vmcnt(4)
  buffer_load_dwordx4 a[104:107], v14, s[36:39], s46 offen nt
  s_waitcnt vmcnt(4)
  buffer_load_dwordx4 a[108:111], v15, s[36:39], s46 offen nt
  s_barrier
  ds_read_b128 v[72:75], v68 offset:2048
  ds_read_b128 v[76:79], v68 offset:2064
  ds_read_b128 v[80:83], v68 offset:2560
  ds_read_b128 v[84:87], v68 offset:2576
  ds_read_b128 v[88:91], v68 offset:3072
  ds_read_b128 v[92:95], v68 offset:3088
  ds_read_b128 v[96:99], v68 offset:3584
  ds_read_b128 v[100:103], v68 offset:3600
  s_waitcnt lgkmcnt(0)
  v_add_f32 v72, v72, v80
  v_add_f32 v88, v88, v96
  v_add_f32 v73, v73, v81
  v_add_f32 v89, v89, v97
  v_add_f32 v74, v74, v82
  v_add_f32 v90, v90, v98
  v_add_f32 v75, v75, v83
  v_add_f32 v91, v91, v99
  v_add_f32 v76, v76, v84
  v_add_f32 v92, v92, v100
  v_add_f32 v77, v77, v85
  v_add_f32 v93, v93, v101
  v_add_f32 v78, v78, v86
  v_add_f32 v94, v94, v102
  v_add_f32 v79, v79, v87
  v_add_f32 v95, v95, v103
  v_add_f32 v72, v72, v88
  v_add_f32 v73, v73, v89
  v_add_f32 v74, v74, v90
  v_add_f32 v75, v75, v91
  v_add_f32 v76, v76, v92
  v_add_f32 v77, v77, v93
  v_add_f32 v78, v78, v94
  v_add_f32 v79, v79, v95
  v_cvt_pk_bf16_f32 v80, v72, v73
  v_cvt_pk_bf16_f32 v81, v74, v75
  v_cvt_pk_bf16_f32 v82, v76, v77
  v_cvt_pk_bf16_f32 v83, v78, v79
  v_cmp_eq_u32 vcc, 0, v69
  s_nop 1
  v_cndmask_b32 v16, 0, v80, vcc
  v_cndmask_b32 v17, 0, v81, vcc
  v_cndmask_b32 v18, 0, v82, vcc
  v_cndmask_b32 v19, 0, v83, vcc
  v_cmp_eq_u32 vcc, 1, v69
  s_nop 1
  v_cndmask_b32 v20, 0, v80, vcc
  v_cndmask_b32 v21, 0, v81, vcc
  v_cndmask_b32 v22, 0, v82, vcc
  v_cndmask_b32 v23, 0, v83, vcc
  v_cmp_eq_u32 vcc, 2, v69
  s_nop 1
  v_cndmask_b32 v24, 0, v80, vcc
  v_cndmask_b32 v25, 0, v81, vcc
  v_cndmask_b32 v26, 0, v82, vcc
  v_cndmask_b32 v27, 0, v83, vcc
  v_cmp_eq_u32 vcc, 3, v69
  s_nop 1
  v_cndmask_b32 v28, 0, v80, vcc
  v_cndmask_b32 v29, 0, v81, vcc
  v_cndmask_b32 v30, 0, v82, vcc
  v_cndmask_b32 v31, 0, v83, vcc
  s_add_u32 s62, s60, 0x9e3779b9
  s_add_u32 s63, s60, 0x7f4a7c15
  s_mov_b64 vcc, 0
L_chunk:
  s_waitcnt vmcnt(23)
  s_cmp_ge_u32 s52, 15
  s_cbranch_scc1 L_final
  s_add_u32 s59, s52, 1
  s_lshl_b32 s58, s59, 3
  s_add_u32 s58, s58, s53
  s_lshr_b32 s48, s58, 2
  s_lshl_b32 s48, s48, 16
  s_and_b32 s59, s58, 3
  s_lshl_b32 s59, s59, 10
  s_add_u32 s48, s48, s59
  s_add_u32 s49, s48, 16384
  s_add_u32 s50, s48, 32768
  s_add_u32 s51, s48, 49152
  s_cmp_ge_u32 s52, 14
  s_cselect_b64 vcc, -1, 0
  s_cbranch_vccnz L_bs0
  s_waitcnt vmcnt(4)
L_bs0:
  buffer_load_dwordx4 a[112:115], v12, s[36:39], s47 offen nt
  v_mfma_f32_16x16x32_bf16 v[32:35], a[0:3], v[16:19], 0
  v_mfma_f32_16x16x32_bf16 v[32:35], a[4:7], v[20:23], v[32:35]
  v_mfma_f32_16x16x32_bf16 v[32:35], a[8:11], v[24:27], v[32:35]
  v_mfma_f32_16x16x32_bf16 v[32:35], a[12:15], v[28:31], v[32:35]
  v_mfma_f32_16x16x32_bf16 v[36:39], a[16:19], v[16:19], 0
  s_cbranch_vccnz L_bs1
  s_waitcnt vmcnt(4)
L_bs1:
  s_waitcnt vmcnt(23)
  buffer_load_dwordx4 a[116:119], v13, s[36:39], s47 offen nt
  v_mfma_f32_16x16x32_bf16 v[36:39], a[20:23], v[20:23], v[36:39]
  s_cbranch_vccnz L_bs2
  s_waitcnt vmcnt(4)
L_bs2:
  s_waitcnt vmcnt(23)
  buffer_load_dwordx4 a[120:123], v14, s[36:39], s47 offen nt
  v_mfma_f32_16x16x32_bf16 v[36:39], a[24:27], v[24:27], v[36:39]
  s_cbranch_vccnz L_bs3
  s_waitcnt vmcnt(4)
L_bs3:
  s_waitcnt vmcnt(23)
  buffer_load_dwordx4 a[124:127], v15, s[36:39], s47 offen nt
  v_mfma_f32_16x16x32_bf16 v[36:39], a[28:31], v[28:31], v[36:39]
  s_cbranch_vccnz L_bs4
  s_waitcnt vmcnt(4)
L_bs4:
  s_waitcnt vmcnt(23)
  buffer_load_dwordx4 a[0:3], v8, s[32:35], s48 offen nt
  v_mfma_f32_16x16x32_bf16 v[40:43], a[32:35], v[16:19], 0
  s_cbranch_vccnz L_bs5
  s_waitcnt vmcnt(4)
L_bs5:
  s_waitcnt vmcnt(23)
  buffer_load_dwordx4 a[4:7], v9, s[32:35], s48 offen nt
  v_mfma_f32_16x16x32_bf16 v[40:43], a[36:39], v[20:23], v[40:43]
  s_cbranch_vccnz L_bs6
  s_waitcnt vmcnt(4)
L_bs6:
  s_waitcnt vmcnt(23)
  buffer_load_dwordx4 a[8:11], v10, s[32:35], s48 offen nt
  v_mfma_f32_16x16x32_bf16 v[40:43], a[40:43], v[24:27], v[40:43]
  s_cbranch_vccnz L_bs7
  s_waitcnt vmcnt(4)
L_bs7:
  s_waitcnt vmcnt(23)
  buffer_load_dwordx4 a[12:15], v11, s[32:35], s48 offen nt
  v_mfma_f32_16x16x32_bf16 v[40:43], a[44:47], v[28:31], v[40:43]
  s_cbranch_vccnz L_bs8
  s_waitcnt vmcnt(4)
L_bs8:
  s_waitcnt vmcnt(23)
  buffer_load_dwordx4 a[16:19], v8, s[32:35], s49 offen nt
  v_mfma_f32_16x16x32_bf16 v[44:47], a[48:51], v[16:19], 0
  s_cbranch_vccnz L_bs9
  s_waitcnt vmcnt(4)
L_bs9:
  s_waitcnt vmcnt(23)
  buffer_load_dwordx4 a[20:23], v9, s[32:35], s49 offen nt
  v_mfma_f32_16x16x32_bf16 v[44:47], a[52:55], v[20:23], v[44:47]
  s_cbranch_vccnz L_bs10
  s_waitcnt vmcnt(4)
L_bs10:
  s_waitcnt vmcnt(23)
  buffer_load_dwordx4 a[24:27], v10, s[32:35], s49 offen nt
  v_mfma_f32_16x16x32_bf16 v[44:47], a[56:59], v[24:27], v[44:47]
  s_cbranch_vccnz L_bs11
  s_waitcnt vmcnt(4)
L_bs11:
  s_waitcnt vmcnt(23)
  buffer_load_dwordx4 a[28:31], v11, s[32:35], s49 offen nt
  v_mfma_f32_16x16x32_bf16 v[44:47], a[60:63], v[28:31], v[44:47]
  s_cbranch_vccnz L_bs12
  s_waitcnt vmcnt(4)
L_bs12:
  s_waitcnt vmcnt(23)
  buffer_load_dwordx4 a[32:35], v8, s[32:35], s50 offen nt
  s_nop 7
  v_cndmask_b32 v72, v32, v37, s[54:55]
  v_cndmask_b32 v73, v42, v47, s[54:55]
  v_cndmask_b32 v68, v72, v73, s[56:57]
  v_cndmask_b32 v72, v36, v33, s[54:55]
  v_cndmask_b32 v73, v46, v43, s[54:55]
  v_cndmask_b32 v69, v72, v73, s[56:57]
  v_cndmask_b32 v72, v40, v45, s[54:55]
  v_cndmask_b32 v73, v34, v39, s[54:55]
  v_cndmask_b32 v70, v72, v73, s[56:57]
  v_cndmask_b32 v72, v44, v41, s[54:55]
  v_cndmask_b32 v73, v38, v35, s[54:55]
  v_cndmask_b32 v71, v72, v73, s[56:57]
  s_nop 1
  v_add_f32_dpp v68, v69, v68 quad_perm:[1,0,3,2] row_mask:0xf bank_mask:0xf
  v_add_f32_dpp v70, v71, v70 quad_perm:[1,0,3,2] row_mask:0xf bank_mask:0xf
  s_nop 1
  v_add_f32_dpp v68, v70, v68 quad_perm:[2,3,0,1] row_mask:0xf bank_mask:0xf
  v_cvt_pk_bf16_f32 v68, 0, v68
  v_mul_f32 v68, 0x3db504f3, v68
  v_cvt_pk_bf16_f32 v68, 0, v68
  v_mov_b32 v69, v68
  s_cbranch_vccnz L_bs13
  s_waitcnt vmcnt(4)
L_bs13:
  s_waitcnt vmcnt(23)
  buffer_load_dwordx4 a[36:39], v9, s[32:35], s50 offen nt
  s_nop 1
  v_max_f32_dpp v69, v69, v69 row_ror:8 row_mask:0xf bank_mask:0xf
  s_nop 1
  v_max_f32_dpp v69, v69, v69 row_ror:4 row_mask:0xf bank_mask:0xf
  s_nop 1
  v_max_f32_dpp v69, v69, v69 row_ror:2 row_mask:0xf bank_mask:0xf
  s_nop 1
  v_max_f32_dpp v69, v69, v69 row_ror:1 row_mask:0xf bank_mask:0xf
  s_nop 1
  v_max_f32_dpp v69, v69, v69 row_bcast:15 row_mask:0xa bank_mask:0xf
  s_nop 1
  v_max_f32_dpp v69, v69, v69 row_bcast:31 row_mask:0xc bank_mask:0xf
  s_cbranch_vccnz L_bs14
  s_waitcnt vmcnt(4)
L_bs14:
  s_waitcnt vmcnt(23)
  buffer_load_dwordx4 a[40:43], v10, s[32:35], s50 offen nt
  s_nop 0
  v_readlane_b32 s58, v69, 63
  s_nop 1
  v_max_f32 v69, s58, v64
  v_sub_f32 v70, v64, v69
  v_sub_f32 v68, v68, v69
  v_mul_f32 v70, 0x3fb8aa3b, v70
  v_mul_f32 v68, 0x3fb8aa3b, v68
  v_exp_f32 v70, v70
  v_exp_f32 v68, v68
  v_mov_b32 v64, v69
  s_cbranch_vccnz L_bs15
  s_waitcnt vmcnt(4)
L_bs15:
  s_waitcnt vmcnt(23)
  buffer_load_dwordx4 a[44:47], v11, s[32:35], s50 offen nt
  v_fma_f32 v65, v65, v70, v68
  v_cvt_pk_bf16_f32 v66, v68, v68
  v_mul_f32 v48, v48, v70
  v_mul_f32 v49, v49, v70
  v_mul_f32 v50, v50, v70
  v_mul_f32 v51, v51, v70
  v_and_b32_dpp v52, v66, v60 row_newbcast:0 row_mask:0xf bank_mask:0xf
  v_and_b32_dpp v53, v66, v61 row_newbcast:0 row_mask:0xf bank_mask:0xf
  v_and_b32_dpp v54, v66, v62 row_newbcast:0 row_mask:0xf bank_mask:0xf
  v_and_b32_dpp v55, v66, v63 row_newbcast:0 row_mask:0xf bank_mask:0xf
  s_cbranch_vccnz L_bs16
  s_waitcnt vmcnt(4)
L_bs16:
  s_waitcnt vmcnt(23)
  buffer_load_dwordx4 a[48:51], v8, s[32:35], s51 offen nt
  v_and_b32_dpp v56, v66, v60 row_newbcast:4 row_mask:0xf bank_mask:0xf
  v_and_b32_dpp v57, v66, v61 row_newbcast:4 row_mask:0xf bank_mask:0xf
  v_and_b32_dpp v58, v66, v62 row_newbcast:4 row_mask:0xf bank_mask:0xf
  v_and_b32_dpp v59, v66, v63 row_newbcast:4 row_mask:0xf bank_mask:0xf
  v_mfma_f32_16x16x32_bf16 v[48:51], v[52:55], a[64:67], v[48:51]
  s_cbranch_vccnz L_bs17
  s_waitcnt vmcnt(4)
L_bs17:
  s_waitcnt vmcnt(23)
  buffer_load_dwordx4 a[52:55], v9, s[32:35], s51 offen nt
  v_and_b32_dpp v52, v66, v60 row_newbcast:8 row_mask:0xf bank_mask:0xf
  v_and_b32_dpp v53, v66, v61 row_newbcast:8 row_mask:0xf bank_mask:0xf
  v_and_b32_dpp v54, v66, v62 row_newbcast:8 row_mask:0xf bank_mask:0xf
  v_and_b32_dpp v55, v66, v63 row_newbcast:8 row_mask:0xf bank_mask:0xf
  v_mfma_f32_16x16x32_bf16 v[48:51], v[56:59], a[68:71], v[48:51]
  s_cbranch_vccnz L_bs18
  s_waitcnt vmcnt(4)
L_bs18:
  s_waitcnt vmcnt(23)
  buffer_load_dwordx4 a[56:59], v10, s[32:35], s51 offen nt
  v_and_b32_dpp v56, v66, v60 row_newbcast:12 row_mask:0xf bank_mask:0xf
  v_and_b32_dpp v57, v66, v61 row_newbcast:12 row_mask:0xf bank_mask:0xf
  v_and_b32_dpp v58, v66, v62 row_newbcast:12 row_mask:0xf bank_mask:0xf
  v_and_b32_dpp v59, v66, v63 row_newbcast:12 row_mask:0xf bank_mask:0xf
  v_mfma_f32_16x16x32_bf16 v[48:51], v[52:55], a[72:75], v[48:51]
  s_cbranch_vccnz L_bs19
  s_waitcnt vmcnt(4)
L_bs19:
  s_waitcnt vmcnt(23)
  buffer_load_dwordx4 a[60:63], v11, s[32:35], s51 offen nt
  v_and_b32_dpp v52, v66, v60 row_newbcast:1 row_mask:0xf bank_mask:0xf
  v_and_b32_dpp v53, v66, v61 row_newbcast:1 row_mask:0xf bank_mask:0xf
  v_and_b32_dpp v54, v66, v62 row_newbcast:1 row_mask:0xf bank_mask:0xf
  v_and_b32_dpp v55, v66, v63 row_newbcast:1 row_mask:0xf bank_mask:0xf
  v_mfma_f32_16x16x32_bf16 v[48:51], v[56:59], a[76:79], v[48:51]
  s_cbranch_vccnz L_bs20
  s_waitcnt vmcnt(4)
L_bs20:
  s_waitcnt vmcnt(23)
  buffer_load_dwordx4 a[64:67], v12, s[36:39], s48 offen nt
  v_and_b32_dpp v56, v66, v60 row_newbcast:5 row_mask:0xf bank_mask:0xf
  v_and_b32_dpp v57, v66, v61 row_newbcast:5 row_mask:0xf bank_mask:0xf
  v_and_b32_dpp v58, v66, v62 row_newbcast:5 row_mask:0xf bank_mask:0xf
  v_and_b32_dpp v59, v66, v63 row_newbcast:5 row_mask:0xf bank_mask:0xf
  v_mfma_f32_16x16x32_bf16 v[48:51], v[52:55], a[80:83], v[48:51]
  s_cbranch_vccnz L_bs21
  s_waitcnt vmcnt(4)
L_bs21:
  s_waitcnt vmcnt(23)
  buffer_load_dwordx4 a[68:71], v13, s[36:39], s48 offen nt
  v_and_b32_dpp v52, v66, v60 row_newbcast:9 row_mask:0xf bank_mask:0xf
  v_and_b32_dpp v53, v66, v61 row_newbcast:9 row_mask:0xf bank_mask:0xf
  v_and_b32_dpp v54, v66, v62 row_newbcast:9 row_mask:0xf bank_mask:0xf
  v_and_b32_dpp v55, v66, v63 row_newbcast:9 row_mask:0xf bank_mask:0xf
  v_mfma_f32_16x16x32_bf16 v[48:51], v[56:59], a[84:87], v[48:51]
  s_cbranch_vccnz L_bs22
  s_waitcnt vmcnt(4)
L_bs22:
  s_waitcnt vmcnt(23)
  buffer_load_dwordx4 a[72:75], v14, s[36:39], s48 offen nt
  v_and_b32_dpp v56, v66, v60 row_newbcast:13 row_mask:0xf bank_mask:0xf
  v_and_b32_dpp v57, v66, v61 row_newbcast:13 row_mask:0xf bank_mask:0xf
  v_and_b32_dpp v58, v66, v62 row_newbcast:13 row_mask:0xf bank_mask:0xf
  v_and_b32_dpp v59, v66, v63 row_newbcast:13 row_mask:0xf bank_mask:0xf
  v_mfma_f32_16x16x32_bf16 v[48:51], v[52:55], a[88:91], v[48:51]
  s_cbranch_vccnz L_bs23
  s_waitcnt vmcnt(4)
L_bs23:
  s_waitcnt vmcnt(23)
  buffer_load_dwordx4 a[76:79], v15, s[36:39], s48 offen nt
  v_and_b32_dpp v52, v66, v60 row_newbcast:2 row_mask:0xf bank_mask:0xf
  v_and_b32_dpp v53, v66, v61 row_newbcast:2 row_mask:0xf bank_mask:0xf
  v_and_b32_dpp v54, v66, v62 row_newbcast:2 row_mask:0xf bank_mask:0xf
  v_and_b32_dpp v55, v66, v63 row_newbcast:2 row_mask:0xf bank_mask:0xf
  v_mfma_f32_16x16x32_bf16 v[48:51], v[56:59], a[92:95], v[48:51]
  s_cbranch_vccnz L_bs24
  s_waitcnt vmcnt(4)
L_bs24:
  s_waitcnt vmcnt(23)
  buffer_load_dwordx4 a[80:83], v12, s[36:39], s49 offen nt
  v_and_b32_dpp v56, v66, v60 row_newbcast:6 row_mask:0xf bank_mask:0xf
  v_and_b32_dpp v57, v66, v61 row_newbcast:6 row_mask:0xf bank_mask:0xf
  v_and_b32_dpp v58, v66, v62 row_newbcast:6 row_mask:0xf bank_mask:0xf
  v_and_b32_dpp v59, v66, v63 row_newbcast:6 row_mask:0xf bank_mask:0xf
  v_mfma_f32_16x16x32_bf16 v[48:51], v[52:55], a[96:99], v[48:51]
  s_cbranch_vccnz L_bs25
  s_waitcnt vmcnt(4)
L_bs25:
  s_waitcnt vmcnt(23)
  buffer_load_dwordx4 a[84:87], v13, s[36:39], s49 offen nt
  v_and_b32_dpp v52, v66, v60 row_newbcast:10 row_mask:0xf bank_mask:0xf
  v_and_b32_dpp v53, v66, v61 row_newbcast:10 row_mask:0xf bank_mask:0xf
  v_and_b32_dpp v54, v66, v62 row_newbcast:10 row_mask:0xf bank_mask:0xf
  v_and_b32_dpp v55, v66, v63 row_newbcast:10 row_mask:0xf bank_mask:0xf
  v_mfma_f32_16x16x32_bf16 v[48:51], v[56:59], a[100:103], v[48:51]
  s_cbranch_vccnz L_bs26
  s_waitcnt vmcnt(4)
L_bs26:
  s_waitcnt vmcnt(23)
  buffer_load_dwordx4 a[88:91], v14, s[36:39], s49 offen nt
  v_and_b32_dpp v56, v66, v60 row_newbcast:14 row_mask:0xf bank_mask:0xf
  v_and_b32_dpp v57, v66, v61 row_newbcast:14 row_mask:0xf bank_mask:0xf
  v_and_b32_dpp v58, v66, v62 row_newbcast:14 row_mask:0xf bank_mask:0xf
  v_and_b32_dpp v59, v66, v63 row_newbcast:14 row_mask:0xf bank_mask:0xf
  v_mfma_f32_16x16x32_bf16 v[48:51], v[52:55], a[104:107], v[48:51]
  s_cbranch_vccnz L_bs27
  s_waitcnt vmcnt(4)
L_bs27:
  s_waitcnt vmcnt(23)
  buffer_load_dwordx4 a[92:95], v15, s[36:39], s49 offen nt
  v_and_b32_dpp v52, v66, v60 row_newbcast:3 row_mask:0xf bank_mask:0xf
  v_and_b32_dpp v53, v66, v61 row_newbcast:3 row_mask:0xf bank_mask:0xf
  v_and_b32_dpp v54, v66, v62 row_newbcast:3 row_mask:0xf bank_mask:0xf
  v_and_b32_dpp v55, v66, v63 row_newbcast:3 row_mask:0xf bank_mask:0xf
  v_mfma_f32_16x16x32_bf16 v[48:51], v[56:59], a[108:111], v[48:51]
  s_cbranch_vccnz L_bs28
  s_waitcnt vmcnt(4)
L_bs28:
  s_waitcnt vmcnt(23)
  buffer_load_dwordx4 a[96:99], v12, s[36:39], s50 offen nt
  v_and_b32_dpp v56, v66, v60 row_newbcast:7 row_mask:0xf bank_mask:0xf
  v_and_b32_dpp v57, v66, v61 row_newbcast:7 row_mask:0xf bank_mask:0xf
  v_and_b32_dpp v58, v66, v62 row_newbcast:7 row_mask:0xf bank_mask:0xf
  v_and_b32_dpp v59, v66, v63 row_newbcast:7 row_mask:0xf bank_mask:0xf
  v_mfma_f32_16x16x32_bf16 v[48:51], v[52:55], a[112:115], v[48:51]
  s_cbranch_vccnz L_bs29
  s_waitcnt vmcnt(4)
L_bs29:
  s_waitcnt vmcnt(23)
  buffer_load_dwordx4 a[100:103], v13, s[36:39], s50 offen nt
  v_and_b32_dpp v52, v66, v60 row_newbcast:11 row_mask:0xf bank_mask:0xf
  v_and_b32_dpp v53, v66, v61 row_newbcast:11 row_mask:0xf bank_mask:0xf
  v_and_b32_dpp v54, v66, v62 row_newbcast:11 row_mask:0xf bank_mask:0xf
  v_and_b32_dpp v55, v66, v63 row_newbcast:11 row_mask:0xf bank_mask:0xf
  v_mfma_f32_16x16x32_bf16 v[48:51], v[56:59], a[116:119], v[48:51]
  s_cbranch_vccnz L_bs30
  s_waitcnt vmcnt(4)
L_bs30:
  s_waitcnt vmcnt(23)
  buffer_load_dwordx4 a[104:107], v14, s[36:39], s50 offen nt
  v_and_b32_dpp v56, v66, v60 row_newbcast:15 row_mask:0xf bank_mask:0xf
  v_and_b32_dpp v57, v66, v61 row_newbcast:15 row_mask:0xf bank_mask:0xf
  v_and_b32_dpp v58, v66, v62 row_newbcast:15 row_mask:0xf bank_mask:0xf
  v_and_b32_dpp v59, v66, v63 row_newbcast:15 row_mask:0xf bank_mask:0xf
  v_mfma_f32_16x16x32_bf16 v[48:51], v[52:55], a[120:123], v[48:51]
  s_cbranch_vccnz L_bs31
  s_waitcnt vmcnt(4)
L_bs31:
  s_waitcnt vmcnt(23)
  buffer_load_dwordx4 a[108:111], v15, s[36:39], s50 offen nt
  s_nop 1
  v_mfma_f32_16x16x32_bf16 v[48:51], v[56:59], a[124:127], v[48:51]
  s_mov_b32 s44, s48
  s_mov_b32 s45, s49
  s_mov_b32 s46, s50
  s_mov_b32 s47, s51
  s_add_u32 s52, s52, 1
  s_branch L_chunk
L_final:
  s_cmp_lg_u32 s3, 0
  s_cbranch_scc1 L_noclaim
  s_cmp_ge_u32 s2, 128
  s_cbranch_scc1 L_noclaim
  v_mov_b32 v116, s62
  v_mov_b32 v117, s63
  s_mov_b64 exec, 1
  buffer_atomic_swap_x2 v[116:117], v5, s[40:43], s64 offen sc0 sc1
  s_mov_b64 exec, -1
L_noclaim:
  buffer_load_dwordx4 a[112:115], v12, s[36:39], s47 offen nt
  buffer_load_dwordx4 a[116:119], v13, s[36:39], s47 offen nt
  buffer_load_dwordx4 a[120:123], v14, s[36:39], s47 offen nt
  buffer_load_dwordx4 a[124:127], v15, s[36:39], s47 offen nt
  v_mfma_f32_16x16x32_bf16 v[32:35], a[0:3], v[16:19], 0
  v_mfma_f32_16x16x32_bf16 v[32:35], a[4:7], v[20:23], v[32:35]
  v_mfma_f32_16x16x32_bf16 v[32:35], a[8:11], v[24:27], v[32:35]
  v_mfma_f32_16x16x32_bf16 v[32:35], a[12:15], v[28:31], v[32:35]
  v_mfma_f32_16x16x32_bf16 v[36:39], a[16:19], v[16:19], 0
  s_waitcnt vmcnt(26)
  v_mfma_f32_16x16x32_bf16 v[36:39], a[20:23], v[20:23], v[36:39]
  s_waitcnt vmcnt(25)
  v_mfma_f32_16x16x32_bf16 v[36:39], a[24:27], v[24:27], v[36:39]
  s_waitcnt vmcnt(24)
  v_mfma_f32_16x16x32_bf16 v[36:39], a[28:31], v[28:31], v[36:39]
  s_waitcnt vmcnt(23)
  v_mfma_f32_16x16x32_bf16 v[40:43], a[32:35], v[16:19], 0
  s_waitcnt vmcnt(22)
  v_mfma_f32_16x16x32_bf16 v[40:43], a[36:39], v[20:23], v[40:43]
  s_waitcnt vmcnt(21)
  v_mfma_f32_16x16x32_bf16 v[40:43], a[40:43], v[24:27], v[40:43]
  s_waitcnt vmcnt(20)
  v_mfma_f32_16x16x32_bf16 v[40:43], a[44:47], v[28:31], v[40:43]
  s_waitcnt vmcnt(19)
  v_mfma_f32_16x16x32_bf16 v[44:47], a[48:51], v[16:19], 0
  s_waitcnt vmcnt(18)
  v_mfma_f32_16x16x32_bf16 v[44:47], a[52:55], v[20:23], v[44:47]
  s_waitcnt vmcnt(17)
  v_mfma_f32_16x16x32_bf16 v[44:47], a[56:59], v[24:27], v[44:47]
  s_waitcnt vmcnt(16)
  v_mfma_f32_16x16x32_bf16 v[44:47], a[60:63], v[28:31], v[44:47]
  s_nop 7
  v_cndmask_b32 v72, v32, v37, s[54:55]
  v_cndmask_b32 v73, v42, v47, s[54:55]
  v_cndmask_b32 v68, v72, v73, s[56:57]
  v_cndmask_b32 v72, v36, v33, s[54:55]
  v_cndmask_b32 v73, v46, v43, s[54:55]
  v_cndmask_b32 v69, v72, v73, s[56:57]
  v_cndmask_b32 v72, v40, v45, s[54:55]
  v_cndmask_b32 v73, v34, v39, s[54:55]
  v_cndmask_b32 v70, v72, v73, s[56:57]
  v_cndmask_b32 v72, v44, v41, s[54:55]
  v_cndmask_b32 v73, v38, v35, s[54:55]
  v_cndmask_b32 v71, v72, v73, s[56:57]
  s_nop 1
  v_add_f32_dpp v68, v69, v68 quad_perm:[1,0,3,2] row_mask:0xf bank_mask:0xf
  v_add_f32_dpp v70, v71, v70 quad_perm:[1,0,3,2] row_mask:0xf bank_mask:0xf
  s_nop 1
  v_add_f32_dpp v68, v70, v68 quad_perm:[2,3,0,1] row_mask:0xf bank_mask:0xf
  v_cvt_pk_bf16_f32 v68, 0, v68
  v_mul_f32 v68, 0x3db504f3, v68
  v_cvt_pk_bf16_f32 v68, 0, v68
  v_mov_b32 v69, v68
  s_nop 1
  v_max_f32_dpp v69, v69, v69 row_ror:8 row_mask:0xf bank_mask:0xf
  s_nop 1
  v_max_f32_dpp v69, v69, v69 row_ror:4 row_mask:0xf bank_mask:0xf
  s_nop 1
  v_max_f32_dpp v69, v69, v69 row_ror:2 row_mask:0xf bank_mask:0xf
  s_nop 1
  v_max_f32_dpp v69, v69, v69 row_ror:1 row_mask:0xf bank_mask:0xf
  s_nop 1
  v_max_f32_dpp v69, v69, v69 row_bcast:15 row_mask:0xa bank_mask:0xf
  s_nop 1
  v_max_f32_dpp v69, v69, v69 row_bcast:31 row_mask:0xc bank_mask:0xf
  s_nop 0
  v_readlane_b32 s58, v69, 63
  s_nop 1
  v_max_f32 v69, s58, v64
  v_sub_f32 v70, v64, v69
  v_sub_f32 v68, v68, v69
  v_mul_f32 v70, 0x3fb8aa3b, v70
  v_mul_f32 v68, 0x3fb8aa3b, v68
  v_exp_f32 v70, v70
  v_exp_f32 v68, v68
  v_mov_b32 v64, v69
  v_fma_f32 v65, v65, v70, v68
  v_cvt_pk_bf16_f32 v66, v68, v68
  v_mul_f32 v48, v48, v70
  v_mul_f32 v49, v49, v70
  v_mul_f32 v50, v50, v70
  v_mul_f32 v51, v51, v70
  v_and_b32_dpp v52, v66, v60 row_newbcast:0 row_mask:0xf bank_mask:0xf
  v_and_b32_dpp v53, v66, v61 row_newbcast:0 row_mask:0xf bank_mask:0xf
  v_and_b32_dpp v54, v66, v62 row_newbcast:0 row_mask:0xf bank_mask:0xf
  v_and_b32_dpp v55, v66, v63 row_newbcast:0 row_mask:0xf bank_mask:0xf
  s_waitcnt vmcnt(15)
  v_and_b32_dpp v56, v66, v60 row_newbcast:4 row_mask:0xf bank_mask:0xf
  v_and_b32_dpp v57, v66, v61 row_newbcast:4 row_mask:0xf bank_mask:0xf
  v_and_b32_dpp v58, v66, v62 row_newbcast:4 row_mask:0xf bank_mask:0xf
  v_and_b32_dpp v59, v66, v63 row_newbcast:4 row_mask:0xf bank_mask:0xf
  v_mfma_f32_16x16x32_bf16 v[48:51], v[52:55], a[64:67], v[48:51]
  s_waitcnt vmcnt(14)
  v_and_b32_dpp v52, v66, v60 row_newbcast:8 row_mask:0xf bank_mask:0xf
  v_and_b32_dpp v53, v66, v61 row_newbcast:8 row_mask:0xf bank_mask:0xf
  v_and_b32_dpp v54, v66, v62 row_newbcast:8 row_mask:0xf bank_mask:0xf
  v_and_b32_dpp v55, v66, v63 row_newbcast:8 row_mask:0xf bank_mask:0xf
  v_mfma_f32_16x16x32_bf16 v[48:51], v[56:59], a[68:71], v[48:51]
  s_waitcnt vmcnt(13)
  v_and_b32_dpp v56, v66, v60 row_newbcast:12 row_mask:0xf bank_mask:0xf
  v_and_b32_dpp v57, v66, v61 row_newbcast:12 row_mask:0xf bank_mask:0xf
  v_and_b32_dpp v58, v66, v62 row_newbcast:12 row_mask:0xf bank_mask:0xf
  v_and_b32_dpp v59, v66, v63 row_newbcast:12 row_mask:0xf bank_mask:0xf
  v_mfma_f32_16x16x32_bf16 v[48:51], v[52:55], a[72:75], v[48:51]
  s_waitcnt vmcnt(12)
  v_and_b32_dpp v52, v66, v60 row_newbcast:1 row_mask:0xf bank_mask:0xf
  v_and_b32_dpp v53, v66, v61 row_newbcast:1 row_mask:0xf bank_mask:0xf
  v_and_b32_dpp v54, v66, v62 row_newbcast:1 row_mask:0xf bank_mask:0xf
  v_and_b32_dpp v55, v66, v63 row_newbcast:1 row_mask:0xf bank_mask:0xf
  v_mfma_f32_16x16x32_bf16 v[48:51], v[56:59], a[76:79], v[48:51]
  s_waitcnt vmcnt(11)
  v_and_b32_dpp v56, v66, v60 row_newbcast:5 row_mask:0xf bank_mask:0xf
  v_and_b32_dpp v57, v66, v61 row_newbcast:5 row_mask:0xf bank_mask:0xf
  v_and_b32_dpp v58, v66, v62 row_newbcast:5 row_mask:0xf bank_mask:0xf
  v_and_b32_dpp v59, v66, v63 row_newbcast:5 row_mask:0xf bank_mask:0xf
  v_mfma_f32_16x16x32_bf16 v[48:51], v[52:55], a[80:83], v[48:51]
  s_waitcnt vmcnt(10)
  v_and_b32_dpp v52, v66, v60 row_newbcast:9 row_mask:0xf bank_mask:0xf
  v_and_b32_dpp v53, v66, v61 row_newbcast:9 row_mask:0xf bank_mask:0xf
  v_and_b32_dpp v54, v66, v62 row_newbcast:9 row_mask:0xf bank_mask:0xf
  v_and_b32_dpp v55, v66, v63 row_newbcast:9 row_mask:0xf bank_mask:0xf
  v_mfma_f32_16x16x32_bf16 v[48:51], v[56:59], a[84:87], v[48:51]
  s_waitcnt vmcnt(9)
  v_and_b32_dpp v56, v66, v60 row_newbcast:13 row_mask:0xf bank_mask:0xf
  v_and_b32_dpp v57, v66, v61 row_newbcast:13 row_mask:0xf bank_mask:0xf
  v_and_b32_dpp v58, v66, v62 row_newbcast:13 row_mask:0xf bank_mask:0xf
  v_and_b32_dpp v59, v66, v63 row_newbcast:13 row_mask:0xf bank_mask:0xf
  v_mfma_f32_16x16x32_bf16 v[48:51], v[52:55], a[88:91], v[48:51]
  s_waitcnt vmcnt(8)
  v_and_b32_dpp v52, v66, v60 row_newbcast:2 row_mask:0xf bank_mask:0xf
  v_and_b32_dpp v53, v66, v61 row_newbcast:2 row_mask:0xf bank_mask:0xf
  v_and_b32_dpp v54, v66, v62 row_newbcast:2 row_mask:0xf bank_mask:0xf
  v_and_b32_dpp v55, v66, v63 row_newbcast:2 row_mask:0xf bank_mask:0xf
  v_mfma_f32_16x16x32_bf16 v[48:51], v[56:59], a[92:95], v[48:51]
  s_waitcnt vmcnt(7)
  v_and_b32_dpp v56, v66, v60 row_newbcast:6 row_mask:0xf bank_mask:0xf
  v_and_b32_dpp v57, v66, v61 row_newbcast:6 row_mask:0xf bank_mask:0xf
  v_and_b32_dpp v58, v66, v62 row_newbcast:6 row_mask:0xf bank_mask:0xf
  v_and_b32_dpp v59, v66, v63 row_newbcast:6 row_mask:0xf bank_mask:0xf
  v_mfma_f32_16x16x32_bf16 v[48:51], v[52:55], a[96:99], v[48:51]
  s_waitcnt vmcnt(6)
  v_and_b32_dpp v52, v66, v60 row_newbcast:10 row_mask:0xf bank_mask:0xf
  v_and_b32_dpp v53, v66, v61 row_newbcast:10 row_mask:0xf bank_mask:0xf
  v_and_b32_dpp v54, v66, v62 row_newbcast:10 row_mask:0xf bank_mask:0xf
  v_and_b32_dpp v55, v66, v63 row_newbcast:10 row_mask:0xf bank_mask:0xf
  v_mfma_f32_16x16x32_bf16 v[48:51], v[56:59], a[100:103], v[48:51]
  s_waitcnt vmcnt(5)
  v_and_b32_dpp v56, v66, v60 row_newbcast:14 row_mask:0xf bank_mask:0xf
  v_and_b32_dpp v57, v66, v61 row_newbcast:14 row_mask:0xf bank_mask:0xf
  v_and_b32_dpp v58, v66, v62 row_newbcast:14 row_mask:0xf bank_mask:0xf
  v_and_b32_dpp v59, v66, v63 row_newbcast:14 row_mask:0xf bank_mask:0xf
  v_mfma_f32_16x16x32_bf16 v[48:51], v[52:55], a[104:107], v[48:51]
  s_waitcnt vmcnt(4)
  v_and_b32_dpp v52, v66, v60 row_newbcast:3 row_mask:0xf bank_mask:0xf
  v_and_b32_dpp v53, v66, v61 row_newbcast:3 row_mask:0xf bank_mask:0xf
  v_and_b32_dpp v54, v66, v62 row_newbcast:3 row_mask:0xf bank_mask:0xf
  v_and_b32_dpp v55, v66, v63 row_newbcast:3 row_mask:0xf bank_mask:0xf
  v_mfma_f32_16x16x32_bf16 v[48:51], v[56:59], a[108:111], v[48:51]
  s_waitcnt vmcnt(3)
  v_and_b32_dpp v56, v66, v60 row_newbcast:7 row_mask:0xf bank_mask:0xf
  v_and_b32_dpp v57, v66, v61 row_newbcast:7 row_mask:0xf bank_mask:0xf
  v_and_b32_dpp v58, v66, v62 row_newbcast:7 row_mask:0xf bank_mask:0xf
  v_and_b32_dpp v59, v66, v63 row_newbcast:7 row_mask:0xf bank_mask:0xf
  v_mfma_f32_16x16x32_bf16 v[48:51], v[52:55], a[112:115], v[48:51]
  s_waitcnt vmcnt(2)
  v_and_b32_dpp v52, v66, v60 row_newbcast:11 row_mask:0xf bank_mask:0xf
  v_and_b32_dpp v53, v66, v61 row_newbcast:11 row_mask:0xf bank_mask:0xf
  v_and_b32_dpp v54, v66, v62 row_newbcast:11 row_mask:0xf bank_mask:0xf
  v_and_b32_dpp v55, v66, v63 row_newbcast:11 row_mask:0xf bank_mask:0xf
  v_mfma_f32_16x16x32_bf16 v[48:51], v[56:59], a[116:119], v[48:51]
  s_waitcnt vmcnt(1)
  v_and_b32_dpp v56, v66, v60 row_newbcast:15 row_mask:0xf bank_mask:0xf
  v_and_b32_dpp v57, v66, v61 row_newbcast:15 row_mask:0xf bank_mask:0xf
  v_and_b32_dpp v58, v66, v62 row_newbcast:15 row_mask:0xf bank_mask:0xf
  v_and_b32_dpp v59, v66, v63 row_newbcast:15 row_mask:0xf bank_mask:0xf
  v_mfma_f32_16x16x32_bf16 v[48:51], v[52:55], a[120:123], v[48:51]
  s_waitcnt vmcnt(0)
  s_nop 1
  v_mfma_f32_16x16x32_bf16 v[48:51], v[56:59], a[124:127], v[48:51]
  s_add_u32 s52, s52, 1
  s_cmp_lg_u32 s3, 0
  s_cbranch_scc1 L_norole
  s_waitcnt vmcnt(0)
  v_readfirstlane_b32 s66, v116
  v_readfirstlane_b32 s67, v117
  s_cmp_eq_u64 s[66:67], s[62:63]
  s_cselect_b32 s65, 255, s65
  s_sub_u32 s58, s2, 85
  s_cmp_ge_u32 s2, 128
  s_cselect_b32 s65, s58, s65
  v_mov_b32 v68, s65
  ds_write_b32 v5, v68 offset:4140
L_norole:
  s_nop 1
  v_add_f32_dpp v65, v65, v65 row_ror:8 row_mask:0xf bank_mask:0xf
  s_nop 1
  v_add_f32_dpp v65, v65, v65 row_ror:4 row_mask:0xf bank_mask:0xf
  s_nop 1
  v_add_f32_dpp v65, v65, v65 row_ror:2 row_mask:0xf bank_mask:0xf
  s_nop 1
  v_add_f32_dpp v65, v65, v65 row_ror:1 row_mask:0xf bank_mask:0xf
  s_nop 1
  v_add_f32_dpp v65, v65, v65 row_bcast:15 row_mask:0xa bank_mask:0xf
  s_nop 1
  v_add_f32_dpp v65, v65, v65 row_bcast:31 row_mask:0xc bank_mask:0xf
  v_and_b32 v72, 15, v0
  v_lshlrev_b32 v72, 5, v72
  v_lshrrev_b32 v73, 4, v0
  v_lshlrev_b32 v73, 4, v73
  v_add_u32 v72, v72, v73
  s_lshl_b32 s58, s3, 9
  v_add_u32 v72, s58, v72
  v_mov_b32 v74, v64
  v_mov_b32 v75, v65
  s_lshl_b32 s58, s3, 3
  v_mov_b32 v73, s58
  s_mov_b32 exec_hi, 0
  ds_write_b128 v72, v[48:51] offset:2048
  s_mov_b32 exec_lo, 0
  s_mov_b32 exec_hi, 0x80000000
  ds_write_b64 v73, v[74:75] offset:4096
  s_mov_b64 exec, -1
  s_waitcnt lgkmcnt(0)
  s_barrier
  s_endpgm
L_tail:
  s_setprio 3
  s_sub_u32 s3, s3, 4
  s_lshl_b32 s64, s29, 1
  s_add_u32 s64, s64, s30
  v_mov_b32 v9, 0
  v_lshlrev_b32 v2, 4, v0
  v_lshrrev_b32 v3, 2, v0
  v_lshlrev_b32 v3, 13, v3
  v_and_b32 v8, 3, v0
  v_lshlrev_b32 v8, 4, v8
  v_add_u32 v3, v3, v8
  v_lshrrev_b32 v6, 4, v0
  v_lshlrev_b32 v6, 10, v6
  v_and_b32 v7, 15, v0
  v_lshlrev_b32 v4, 6, v7
  v_add_u32 v4, v4, v6
  v_lshlrev_b32 v5, 3, v7
  v_add_u32 v5, v5, v6
  s_lshl_b32 s68, s64, 7
  v_add_u32 v5, s68, v5
  s_lshl_b32 s70, s64, 19
  s_lshl_b32 s71, s28, 8
  s_add_u32 s70, s70, s71
  s_lshl_b32 s71, s3, 6
  s_add_u32 s70, s70, s71
  s_lshl_b32 s72, s3, 12
  s_add_u32 s72, s72, 16384
  s_waitcnt lgkmcnt(0)
  s_load_dword s50, s[26:27], 0xff000
  s_mov_b32 s32, s4
  s_mov_b32 s33, s5
  s_mov_b32 s34, 4096
  s_mov_b32 s35, 0x20000
  buffer_load_dwordx4 v[64:67], v4, s[32:35], 0 offen offset:0
  buffer_load_dwordx4 v[68:71], v4, s[32:35], 0 offen offset:16
  buffer_load_dwordx4 v[72:75], v4, s[32:35], 0 offen offset:32
  buffer_load_dwordx4 v[76:79], v4, s[32:35], 0 offen offset:48
  buffer_load_dwordx2 v[80:81], v5, s[32:35], 0 offen
  s_mov_b32 s36, s10
  s_mov_b32 s37, s11
  s_mov_b32 s38, 4194304
  s_mov_b32 s39, 0x20000
  s_add_u32 m0, s72, 0
  s_add_u32 s73, s70, 0
  buffer_load_dwordx4 v3, s[36:39], s73 offen nt lds
  s_add_u32 m0, s72, 1024
  s_add_u32 s73, s70, 131072
  buffer_load_dwordx4 v3, s[36:39], s73 offen nt lds
  s_add_u32 m0, s72, 2048
  s_add_u32 s73, s70, 262144
  buffer_load_dwordx4 v3, s[36:39], s73 offen nt lds
  s_add_u32 m0, s72, 3072
  s_add_u32 s73, s70, 393216
  buffer_load_dwordx4 v3, s[36:39], s73 offen nt lds
  v_mov_b32 v13, s72
  s_mov_b32 s44, s26
  s_mov_b32 s45, s27
  s_mov_b32 s46, 2883584
  s_mov_b32 s47, 0x20000
  v_lshrrev_b32 v11, 4, v0
  v_lshlrev_b32 v11, 3, v11
  v_lshrrev_b32 v12, 2, v0
  v_and_b32 v12, 3, v12
  v_add_u32 v11, v11, v12
  v_and_b32 v12, 3, v0
  v_lshlrev_b32 v12, 3, v12
  v_lshlrev_b32 v10, 6, v11
  v_add_u32 v13, v13, v10
  v_add_u32 v13, v13, v12
  s_mul_i32 s74, s3, 576
  v_lshrrev_b32 v15, 4, v0
  v_mul_u32_u24 v15, 144, v15
  v_lshlrev_b32 v7, 3, v7
  v_add_u32 v15, v15, v7
  v_add_u32 v15, s74, v15
  v_and_b32 v14, 3, v0
  v_mul_u32_u24 v14, 144, v14
  v_lshrrev_b32 v7, 4, v0
  v_lshlrev_b32 v7, 4, v7
  v_add_u32 v14, v14, v7
  v_add_u32 v14, s74, v14
  s_waitcnt vmcnt(4)
  v_lshlrev_b32 v24, 16, v64
  v_and_b32 v25, 0xffff0000, v64
  v_lshlrev_b32 v26, 16, v65
  v_and_b32 v27, 0xffff0000, v65
  v_lshlrev_b32 v28, 16, v66
  v_and_b32 v29, 0xffff0000, v66
  v_lshlrev_b32 v30, 16, v67
  v_and_b32 v31, 0xffff0000, v67
  v_lshlrev_b32 v32, 16, v68
  v_and_b32 v33, 0xffff0000, v68
  v_lshlrev_b32 v34, 16, v69
  v_and_b32 v35, 0xffff0000, v69
  v_lshlrev_b32 v36, 16, v70
  v_and_b32 v37, 0xffff0000, v70
  v_lshlrev_b32 v38, 16, v71
  v_and_b32 v39, 0xffff0000, v71
  v_lshlrev_b32 v40, 16, v72
  v_and_b32 v41, 0xffff0000, v72
  v_lshlrev_b32 v42, 16, v73
  v_and_b32 v43, 0xffff0000, v73
  v_lshlrev_b32 v44, 16, v74
  v_and_b32 v45, 0xffff0000, v74
  v_lshlrev_b32 v46, 16, v75
  v_and_b32 v47, 0xffff0000, v75
  v_lshlrev_b32 v48, 16, v76
  v_and_b32 v49, 0xffff0000, v76
  v_lshlrev_b32 v50, 16, v77
  v_and_b32 v51, 0xffff0000, v77
  v_lshlrev_b32 v52, 16, v78
  v_and_b32 v53, 0xffff0000, v78
  v_lshlrev_b32 v54, 16, v79
  v_and_b32 v55, 0xffff0000, v79
  v_pk_add_f32 v[56:57], v[24:25], v[26:27]
  v_pk_add_f32 v[58:59], v[28:29], v[30:31]
  v_pk_add_f32 v[56:57], v[56:57], v[32:33]
  v_pk_add_f32 v[58:59], v[58:59], v[34:35]
  v_pk_add_f32 v[56:57], v[56:57], v[36:37]
  v_pk_add_f32 v[58:59], v[58:59], v[38:39]
  v_pk_add_f32 v[56:57], v[56:57], v[40:41]
  v_pk_add_f32 v[58:59], v[58:59], v[42:43]
  v_pk_add_f32 v[56:57], v[56:57], v[44:45]
  v_pk_add_f32 v[58:59], v[58:59], v[46:47]
  v_pk_add_f32 v[56:57], v[56:57], v[48:49]
  v_pk_add_f32 v[58:59], v[58:59], v[50:51]
  v_pk_add_f32 v[56:57], v[56:57], v[52:53]
  v_pk_add_f32 v[58:59], v[58:59], v[54:55]
  v_pk_add_f32 v[56:57], v[56:57], v[58:59]
  v_add_f32 v56, v56, v57
  s_nop 1
  v_add_f32_dpp v56, v56, v56 row_ror:8 row_mask:0xf bank_mask:0xf
  s_nop 1
  v_add_f32_dpp v56, v56, v56 row_ror:4 row_mask:0xf bank_mask:0xf
  s_nop 1
  v_add_f32_dpp v56, v56, v56 row_ror:2 row_mask:0xf bank_mask:0xf
  s_nop 1
  v_add_f32_dpp v56, v56, v56 row_ror:1 row_mask:0xf bank_mask:0xf
  v_mul_f32 v56, 0x3b000000, v56
  v_mov_b32 v57, v56
  v_pk_add_f32 v[60:61], v[24:25], v[56:57] neg_lo:[0,1] neg_hi:[0,1]
  v_pk_mul_f32 v[58:59], v[60:61], v[60:61]
  v_pk_add_f32 v[60:61], v[26:27], v[56:57] neg_lo:[0,1] neg_hi:[0,1]
  v_pk_fma_f32 v[58:59], v[60:61], v[60:61], v[58:59]
  v_pk_add_f32 v[60:61], v[28:29], v[56:57] neg_lo:[0,1] neg_hi:[0,1]
  v_pk_fma_f32 v[58:59], v[60:61], v[60:61], v[58:59]
  v_pk_add_f32 v[60:61], v[30:31], v[56:57] neg_lo:[0,1] neg_hi:[0,1]
  v_pk_fma_f32 v[58:59], v[60:61], v[60:61], v[58:59]
  v_pk_add_f32 v[60:61], v[32:33], v[56:57] neg_lo:[0,1] neg_hi:[0,1]
  v_pk_fma_f32 v[58:59], v[60:61], v[60:61], v[58:59]
  v_pk_add_f32 v[60:61], v[34:35], v[56:57] neg_lo:[0,1] neg_hi:[0,1]
  v_pk_fma_f32 v[58:59], v[60:61], v[60:61], v[58:59]
  v_pk_add_f32 v[60:61], v[36:37], v[56:57] neg_lo:[0,1] neg_hi:[0,1]
  v_pk_fma_f32 v[58:59], v[60:61], v[60:61], v[58:59]
  v_pk_add_f32 v[60:61], v[38:39], v[56:57] neg_lo:[0,1] neg_hi:[0,1]
  v_pk_fma_f32 v[58:59], v[60:61], v[60:61], v[58:59]
  v_pk_add_f32 v[60:61], v[40:41], v[56:57] neg_lo:[0,1] neg_hi:[0,1]
  v_pk_fma_f32 v[58:59], v[60:61], v[60:61], v[58:59]
  v_pk_add_f32 v[60:61], v[42:43], v[56:57] neg_lo:[0,1] neg_hi:[0,1]
  v_pk_fma_f32 v[58:59], v[60:61], v[60:61], v[58:59]
  v_pk_add_f32 v[60:61], v[44:45], v[56:57] neg_lo:[0,1] neg_hi:[0,1]
  v_pk_fma_f32 v[58:59], v[60:61], v[60:61], v[58:59]
  v_pk_add_f32 v[60:61], v[46:47], v[56:57] neg_lo:[0,1] neg_hi:[0,1]
  v_pk_fma_f32 v[58:59], v[60:61], v[60:61], v[58:59]
  v_pk_add_f32 v[60:61], v[48:49], v[56:57] neg_lo:[0,1] neg_hi:[0,1]
  v_pk_fma_f32 v[58:59], v[60:61], v[60:61], v[58:59]
  v_pk_add_f32 v[60:61], v[50:51], v[56:57] neg_lo:[0,1] neg_hi:[0,1]
  v_pk_fma_f32 v[58:59], v[60:61], v[60:61], v[58:59]
  v_pk_add_f32 v[60:61], v[52:53], v[56:57] neg_lo:[0,1] neg_hi:[0,1]
  v_pk_fma_f32 v[58:59], v[60:61], v[60:61], v[58:59]
  v_pk_add_f32 v[60:61], v[54:55], v[56:57] neg_lo:[0,1] neg_hi:[0,1]
  v_pk_fma_f32 v[58:59], v[60:61], v[60:61], v[58:59]
  v_add_f32 v58, v58, v59
  v_cvt_pk_bf16_f32 v56, 0, v56
  v_lshlrev_b32 v24, 16, v80
  v_and_b32 v25, 0xffff0000, v80
  v_lshlrev_b32 v26, 16, v81
  v_and_b32 v27, 0xffff0000, v81
  v_add_f32_dpp v58, v58, v58 row_ror:8 row_mask:0xf bank_mask:0xf
  v_sub_f32 v24, v24, v56
  v_sub_f32 v25, v25, v56
  v_add_f32_dpp v58, v58, v58 row_ror:4 row_mask:0xf bank_mask:0xf
  v_sub_f32 v26, v26, v56
  v_sub_f32 v27, v27, v56
  v_add_f32_dpp v58, v58, v58 row_ror:2 row_mask:0xf bank_mask:0xf
  v_cvt_pk_bf16_f32 v24, 0, v24
  v_cvt_pk_bf16_f32 v25, 0, v25
  v_add_f32_dpp v58, v58, v58 row_ror:1 row_mask:0xf bank_mask:0xf
  v_cvt_pk_bf16_f32 v26, 0, v26
  v_cvt_pk_bf16_f32 v27, 0, v27
  v_mul_f32 v58, 0x3b000000, v58
  v_cvt_pk_bf16_f32 v58, 0, v58
  v_add_f32 v58, 0x3727c5ac, v58
  v_cvt_pk_bf16_f32 v58, 0, v58
  v_sqrt_f32 v58, v58
  s_nop 0
  v_cvt_pk_bf16_f32 v58, 0, v58
  v_rcp_f32 v59, v58
  s_nop 0
  v_mul_f32 v60, v24, v59
  v_fma_f32 v24, -v60, v58, v24
  v_fma_f32 v24, v24, v59, v60
  v_mul_f32 v60, v25, v59
  v_fma_f32 v25, -v60, v58, v25
  v_fma_f32 v25, v25, v59, v60
  v_mul_f32 v60, v26, v59
  v_fma_f32 v26, -v60, v58, v26
  v_fma_f32 v26, v26, v59, v60
  v_mul_f32 v60, v27, v59
  v_fma_f32 v27, -v60, v58, v27
  v_fma_f32 v27, v27, v59, v60
  v_cvt_pk_bf16_f32 v24, v24, v25
  v_cvt_pk_bf16_f32 v25, v26, v27
  ds_write_b64 v15, v[24:25] offset:5248
  s_waitcnt vmcnt(0) lgkmcnt(0)
  ds_read_b128 v[24:27], v14 offset:5248
  ds_read_b128 v[28:31], v14 offset:5312
  ds_read_b64_tr_b16 v[40:41], v13 offset:0
  ds_read_b64_tr_b16 v[42:43], v13 offset:256
  ds_read_b64_tr_b16 v[44:45], v13 offset:32
  ds_read_b64_tr_b16 v[46:47], v13 offset:288
  ds_read_b64_tr_b16 v[48:49], v13 offset:2048
  ds_read_b64_tr_b16 v[50:51], v13 offset:2304
  ds_read_b64_tr_b16 v[52:53], v13 offset:2080
  ds_read_b64_tr_b16 v[54:55], v13 offset:2336
  s_add_u32 s68, s50, 0x9e3779b9
  s_add_u32 s69, s50, 0x7f4a7c15
  v_mov_b32 v100, s68
  v_mov_b32 v101, s69
  v_mov_b32 v66, v100
  v_mov_b32 v67, v101
  v_mov_b32 v70, v100
  v_mov_b32 v71, v101
  v_mov_b32 v74, v100
  v_mov_b32 v75, v101
  v_mov_b32 v78, v100
  v_mov_b32 v79, v101
  s_lshl_b32 s70, s28, 15
  s_lshl_b32 s71, s64, 10
  s_add_u32 s70, s70, s71
  s_lshl_b32 s71, s3, 8
  s_add_u32 s70, s70, s71
  s_add_u32 s70, s70, 1048576
  s_waitcnt lgkmcnt(0)
  v_mfma_f32_16x16x32_bf16 v[56:59], v[24:27], v[40:43], 0
  v_mfma_f32_16x16x32_bf16 v[60:63], v[24:27], v[44:47], 0
  v_mfma_f32_16x16x32_bf16 v[56:59], v[28:31], v[48:51], v[56:59]
  v_mfma_f32_16x16x32_bf16 v[60:63], v[28:31], v[52:55], v[60:63]
  s_lshl_b32 s72, s28, 15
  s_lshl_b32 s73, s29, 13
  s_add_u32 s72, s72, s73
  s_lshl_b32 s73, s3, 11
  s_add_u32 s72, s72, s73
  s_add_u32 s72, s72, 1048576
  s_nop 4
  v_mov_b32 v64, v56
  v_mov_b32 v65, v60
  v_mov_b32 v68, v57
  v_mov_b32 v69, v61
  v_mov_b32 v72, v58
  v_mov_b32 v73, v62
  v_mov_b32 v76, v59
  v_mov_b32 v77, v63
  s_mov_b64 exec, 0xffff
  buffer_store_dwordx4 v[64:67], v2, s[44:47], s70 offen sc0 sc1
  s_add_u32 s70, s70, 8192
  buffer_store_dwordx4 v[68:71], v2, s[44:47], s70 offen sc0 sc1
  s_add_u32 s70, s70, 8192
  buffer_store_dwordx4 v[72:75], v2, s[44:47], s70 offen sc0 sc1
  s_add_u32 s70, s70, 8192
  buffer_store_dwordx4 v[76:79], v2, s[44:47], s70 offen sc0 sc1
  s_mov_b64 exec, -1
  v_lshrrev_b32 v8, 4, v0
  v_lshlrev_b32 v8, 7, v8
  v_and_b32 v7, 15, v0
  v_lshlrev_b32 v7, 2, v7
  v_add_u32 v8, v8, v7
  s_lshl_b32 s73, s3, 9
  v_add_u32 v8, s73, v8
  v_add_u32 v8, 2048, v8
  s_waitcnt vmcnt(0)
  s_mov_b32 s75, 0
L_qpoll:
  buffer_load_dwordx4 v[24:27], v2, s[44:47], s72 offen sc0 sc1
  buffer_load_dwordx4 v[28:31], v2, s[44:47], s72 offen offset:1024 sc0 sc1
  s_waitcnt vmcnt(0)
  v_cmp_ne_u64 vcc, v[26:27], v[100:101]
  v_cmp_ne_u64 s[76:77], v[30:31], v[100:101]
  s_or_b64 s[76:77], vcc, s[76:77]
  s_cbranch_scc0 L_qpoll_done
  s_add_u32 s75, s75, 1
  s_cmp_lt_u32 s75, 262144
  s_cbranch_scc1 L_qpoll
L_qpoll_done:
  v_add_f32 v24, v24, v28
  v_add_f32 v25, v25, v29
  ds_write2_b32 v8, v24, v25 offset1:16
  s_waitcnt lgkmcnt(0)
  s_barrier
  s_lshl_b32 s68, s28, 17
  s_add_u32 s40, s12, s68
  s_addc_u32 s41, s13, 0
  s_mov_b32 s42, 131072
  s_mov_b32 s43, 0x20000
  v_lshrrev_b32 v3, 3, v0
  v_lshlrev_b32 v3, 10, v3
  v_and_b32 v8, 7, v0
  v_lshlrev_b32 v8, 4, v8
  v_add_u32 v3, v3, v8
  s_lshl_b32 s68, s64, 7
  s_lshl_b32 s69, s3, 15
  s_add_u32 s68, s68, s69
  s_lshl_b32 s70, s3, 12
  s_add_u32 s70, s70, 32768
  s_add_u32 m0, s70, 0
  s_add_u32 s71, s68, 0
  buffer_load_dwordx4 v3, s[40:43], s71 offen nt lds
  s_add_u32 m0, s70, 1024
  s_add_u32 s71, s68, 8192
  buffer_load_dwordx4 v3, s[40:43], s71 offen nt lds
  s_add_u32 m0, s70, 2048
  s_add_u32 s71, s68, 16384
  buffer_load_dwordx4 v3, s[40:43], s71 offen nt lds
  s_add_u32 m0, s70, 3072
  s_add_u32 s71, s68, 24576
  buffer_load_dwordx4 v3, s[40:43], s71 offen nt lds
  s_cmp_lg_u32 s3, 0
  s_cbranch_scc1 L_ptd
  s_load_dword s67, s[22:23], 0
  s_load_dword s67, s[16:17], 0
  s_load_dword s67, s[18:19], 0
  s_load_dword s67, s[20:21], 0
L_ptd:
  s_lshl_b32 s65, s28, 2
  s_add_u32 s65, s65, s29
  s_lshl_b32 s65, s65, 1
  s_add_u32 s65, s65, s30
  s_mov_b32 s32, s4
  s_mov_b32 s33, s5
  s_mov_b32 s34, 4096
  s_mov_b32 s35, 0x20000
  s_mov_b32 s52, s22
  s_mov_b32 s53, s23
  s_mov_b32 s54, 4096
  s_mov_b32 s55, 0x20000
  s_cmp_lt_u32 s2, 128
  s_cbranch_scc1 L_nox
  s_cmp_lg_u32 s3, 0
  s_cbranch_scc1 L_nox
  v_and_b32 v6, 3, v0
  v_lshlrev_b32 v4, 1, v6
  s_sub_u32 s73, s2, 128
  s_lshl_b32 s73, s73, 3
  buffer_load_ushort v102, v4, s[32:35], s73 offen offset:0
  buffer_load_ushort v103, v4, s[32:35], s73 offen offset:1024
  buffer_load_ushort v104, v4, s[32:35], s73 offen offset:2048
  buffer_load_ushort v105, v4, s[32:35], s73 offen offset:3072
  s_waitcnt vmcnt(0)
  v_lshlrev_b32 v102, 16, v102
  v_lshlrev_b32 v103, 16, v103
  v_lshlrev_b32 v104, 16, v104
  v_lshlrev_b32 v105, 16, v105
L_nox:
  v_lshrrev_b32 v11, 4, v0
  v_lshlrev_b32 v11, 3, v11
  v_lshrrev_b32 v12, 2, v0
  v_and_b32 v12, 3, v12
  v_add_u32 v11, v11, v12
  v_and_b32 v12, 3, v0
  v_lshlrev_b32 v12, 3, v12
  s_lshl_b32 s70, s3, 5
  s_add_u32 s70, s70, 32768
  v_lshlrev_b32 v13, 7, v11
  v_add_u32 v13, v13, v12
  v_add_u32 v13, s70, v13
  s_waitcnt vmcnt(0)
  v_lshlrev_b32 v2, 3, v0
  s_lshl_b32 s71, s65, 10
  s_add_u32 s71, s71, 262144
  s_lshl_b32 s68, s28, 2
  s_add_u32 s68, s68, s3
  s_lshl_b32 s73, s68, 11
  s_add_u32 s73, s73, 262144
  v_and_b32 v14, 3, v0
  v_mul_u32_u24 v14, 272, v14
  v_lshrrev_b32 v15, 4, v0
  v_lshlrev_b32 v15, 4, v15
  v_add_u32 v14, v14, v15
  v_lshlrev_b32 v15, 2, v0
  s_mul_i32 s69, s3, 272
  v_add_u32 v15, s69, v15
  s_lshl_b32 s69, s28, 13
  s_lshl_b32 s76, s64, 10
  s_add_u32 s69, s69, s76
  s_lshl_b32 s76, s3, 8
  s_add_u32 s69, s69, s76
  v_lshlrev_b32 v4, 4, v0
  s_mov_b32 s48, 0xaaaaaaaa
  s_mov_b32 s49, 0xaaaaaaaa
  v_mov_b32 v55, v100
  v_mov_b32 v59, v100
  s_mov_b32 s61, 0x07060503
  s_mov_b32 s62, 0x07060502
  s_mov_b32 s63, 0x07060501
  s_mov_b32 s82, 0x04000c0c
  s_mov_b32 s83, 0x0706000c
  s_waitcnt lgkmcnt(0)
  s_barrier
L_endcode:
  ds_read_b32 v16, v9 offset:4140
  ds_read_b64_tr_b16 a[96:97], v13 offset:0
  ds_read_b64_tr_b16 a[98:99], v13 offset:512
  ds_read_b64_tr_b16 a[100:101], v13 offset:4096
  ds_read_b64_tr_b16 a[102:103], v13 offset:4608
  ds_read_b64_tr_b16 a[104:105], v13 offset:8192
  ds_read_b64_tr_b16 a[106:107], v13 offset:8704
  ds_read_b64_tr_b16 a[108:109], v13 offset:12288
  ds_read_b64_tr_b16 a[110:111], v13 offset:12800
  s_cmp_lg_u32 s3, s29
  s_cbranch_scc1 L_noop
  ds_read_b64 v[24:25], v2 offset:2048
  ds_read_b64 v[26:27], v2 offset:2560
  ds_read_b64 v[28:29], v2 offset:3072
  ds_read_b64 v[30:31], v2 offset:3584
  ds_read_b128 v[40:43], v9 offset:4096
  ds_read_b128 v[44:47], v9 offset:4112
  s_waitcnt lgkmcnt(0)
  v_max_f32 v48, v40, v42
  v_max3_f32 v48, v48, v44, v46
  v_sub_f32 v32, v40, v48
  v_sub_f32 v33, v42, v48
  v_sub_f32 v34, v44, v48
  v_sub_f32 v35, v46, v48
  v_mul_f32 v32, 0x3fb8aa3b, v32
  v_mul_f32 v33, 0x3fb8aa3b, v33
  v_mul_f32 v34, 0x3fb8aa3b, v34
  v_mul_f32 v35, 0x3fb8aa3b, v35
  v_exp_f32 v32, v32
  v_exp_f32 v33, v33
  v_exp_f32 v34, v34
  v_exp_f32 v35, v35
  s_nop 0
  v_mul_f32 v49, v32, v41
  v_mul_f32 v52, v32, v24
  v_mul_f32 v53, v32, v25
  v_fmac_f32 v49, v33, v43
  v_fmac_f32 v52, v33, v26
  v_fmac_f32 v53, v33, v27
  v_fmac_f32 v49, v34, v45
  v_fmac_f32 v52, v34, v28
  v_fmac_f32 v53, v34, v29
  v_fmac_f32 v49, v35, v47
  v_fmac_f32 v52, v35, v30
  v_fmac_f32 v53, v35, v31
  v_cndmask_b32 v54, v48, v49, s[48:49]
  buffer_store_dwordx4 v[52:55], v4, s[44:47], s71 offen sc0 sc1
L_noop:
  s_waitcnt lgkmcnt(0)
  v_readfirstlane_b32 s66, v16
  s_cmp_ge_u32 s66, 43
  s_cbranch_scc1 L_nodma
  s_mov_b32 s56, s16
  s_mov_b32 s57, s17
  s_mov_b32 s58, 1409024
  s_mov_b32 s59, 0x20000
  s_mov_b32 s36, s18
  s_mov_b32 s37, s19
  s_mov_b32 s38, 1409024
  s_mov_b32 s39, 0x20000
  s_mov_b32 s40, s20
  s_mov_b32 s41, s21
  s_mov_b32 s42, 1409024
  s_mov_b32 s43, 0x20000
  v_lshrrev_b32 v3, 2, v0
  v_mul_u32_u24 v3, 2752, v3
  v_and_b32 v8, 3, v0
  v_lshlrev_b32 v8, 4, v8
  v_add_u32 v3, v3, v8
  s_mul_i32 s80, s3, 352256
  s_lshl_b32 s81, s66, 6
  s_add_u32 s80, s80, s81
  s_lshl_b32 s81, s3, 13
  s_add_u32 s82, s81, 49152
  s_add_u32 m0, s82, 0
  s_add_u32 s83, s80, 0
  buffer_load_dwordx4 v3, s[56:59], s83 offen nt lds
  s_add_u32 m0, s82, 32768
  s_nop 0
  buffer_load_dwordx4 v3, s[36:39], s83 offen nt lds
  s_add_u32 m0, s82, 1024
  s_add_u32 s83, s80, 44032
  buffer_load_dwordx4 v3, s[56:59], s83 offen nt lds
  s_add_u32 m0, s82, 33792
  s_nop 0
  buffer_load_dwordx4 v3, s[36:39], s83 offen nt lds
  s_add_u32 m0, s82, 2048
  s_add_u32 s83, s80, 88064
  buffer_load_dwordx4 v3, s[56:59], s83 offen nt lds
  s_add_u32 m0, s82, 34816
  s_nop 0
  buffer_load_dwordx4 v3, s[36:39], s83 offen nt lds
  s_add_u32 m0, s82, 3072
  s_add_u32 s83, s80, 132096
  buffer_load_dwordx4 v3, s[56:59], s83 offen nt lds
  s_add_u32 m0, s82, 35840
  s_nop 0
  buffer_load_dwordx4 v3, s[36:39], s83 offen nt lds
  s_add_u32 m0, s82, 4096
  s_add_u32 s83, s80, 176128
  buffer_load_dwordx4 v3, s[56:59], s83 offen nt lds
  s_add_u32 m0, s82, 36864
  s_nop 0
  buffer_load_dwordx4 v3, s[36:39], s83 offen nt lds
  s_add_u32 m0, s82, 5120
  s_add_u32 s83, s80, 220160
  buffer_load_dwordx4 v3, s[56:59], s83 offen nt lds
  s_add_u32 m0, s82, 37888
  s_nop 0
  buffer_load_dwordx4 v3, s[36:39], s83 offen nt lds
  s_add_u32 m0, s82, 6144
  s_add_u32 s83, s80, 264192
  buffer_load_dwordx4 v3, s[56:59], s83 offen nt lds
  s_add_u32 m0, s82, 38912
  s_nop 0
  buffer_load_dwordx4 v3, s[36:39], s83 offen nt lds
  s_add_u32 m0, s82, 7168
  s_add_u32 s83, s80, 308224
  buffer_load_dwordx4 v3, s[56:59], s83 offen nt lds
  s_add_u32 m0, s82, 39936
  s_nop 0
  buffer_load_dwordx4 v3, s[36:39], s83 offen nt lds
L_nodma:
  s_mov_b32 s75, 0
L_opoll:
  buffer_load_dwordx4 v[24:27], v4, s[44:47], s73 offen sc0 sc1
  buffer_load_dwordx4 v[28:31], v4, s[44:47], s73 offen offset:1024 sc0 sc1
  s_waitcnt vmcnt(0)
  v_cmp_ne_u32 vcc, v27, v100
  v_cmp_ne_u32 s[76:77], v31, v100
  s_or_b64 s[76:77], vcc, s[76:77]
  s_cbranch_scc0 L_opoll_done
  s_add_u32 s75, s75, 1
  s_cmp_lt_u32 s75, 262144
  s_cbranch_scc1 L_opoll
L_opoll_done:
  v_mov_b32_dpp v32, v26 quad_perm:[0,0,2,2] row_mask:0xf bank_mask:0xf
  v_mov_b32_dpp v33, v26 quad_perm:[1,1,3,3] row_mask:0xf bank_mask:0xf
  v_mov_b32_dpp v34, v30 quad_perm:[0,0,2,2] row_mask:0xf bank_mask:0xf
  v_mov_b32_dpp v35, v30 quad_perm:[1,1,3,3] row_mask:0xf bank_mask:0xf
  v_max_f32 v40, v32, v34
  v_sub_f32 v41, v32, v40
  v_sub_f32 v42, v34, v40
  v_mul_f32 v41, 0x3fb8aa3b, v41
  v_mul_f32 v42, 0x3fb8aa3b, v42
  v_exp_f32 v41, v41
  v_exp_f32 v42, v42
  s_nop 0
  v_mul_f32 v43, v41, v33
  v_fmac_f32 v43, v42, v35
  v_rcp_f32 v43, v43
  s_nop 0
  v_mul_f32 v41, v41, v43
  v_mul_f32 v42, v42, v43
  v_mul_f32 v44, v41, v24
  v_mul_f32 v45, v41, v25
  v_fmac_f32 v44, v42, v28
  v_fmac_f32 v45, v42, v29
  v_cvt_pk_bf16_f32 v44, v44, v45
  ds_write_b32 v15, v44 offset:4160
  s_waitcnt lgkmcnt(0)
  s_barrier
  ds_read_b128 v[24:27], v14 offset:4160
  ds_read_b128 v[28:31], v14 offset:4224
  ds_read_b128 v[32:35], v14 offset:4288
  ds_read_b128 v[36:39], v14 offset:4352
  s_waitcnt lgkmcnt(3)
  v_mfma_f32_16x16x32_bf16 v[40:43], v[24:27], a[96:99], 0
  s_waitcnt lgkmcnt(2)
  v_mfma_f32_16x16x32_bf16 v[40:43], v[28:31], a[100:103], v[40:43]
  s_waitcnt lgkmcnt(1)
  v_mfma_f32_16x16x32_bf16 v[40:43], v[32:35], a[104:107], v[40:43]
  s_waitcnt lgkmcnt(0)
  v_mfma_f32_16x16x32_bf16 v[40:43], v[36:39], a[108:111], v[40:43]
  s_mov_b64 exec, 0xffff
  s_nop 7
  v_perm_b32 v56, v40, v43, s61
  v_perm_b32 v57, v41, v43, s62
  v_perm_b32 v58, v42, v43, s63
  buffer_store_dwordx4 v[56:59], v4, s[44:47], s69 offen sc0 sc1
  s_mov_b64 exec, -1
  s_cmp_lt_u32 s66, 43
  s_cbranch_scc1 L_ffn
  s_cmp_ge_u32 s66, 171
  s_cbranch_scc1 L_fin
  s_cmp_lg_u32 s3, 0
  s_cbranch_scc1 L_fin
  s_sub_u32 s68, s66, 43
  v_lshrrev_b32 v5, 2, v0
  v_and_b32 v6, 3, v0
  v_lshlrev_b32 v2, 13, v5
  v_lshlrev_b32 v3, 4, v6
  v_add_u32 v2, v2, v3
  s_lshl_b32 s71, s68, 6
  s_add_u32 s72, s71, 131072
  s_lshl_b32 s80, s68, 6
  s_add_u32 s80, s80, 884736
  v_mov_b32 v10, v100
  v_mov_b32 v11, v101
  s_mov_b32 s75, 0
L_r1poll:
  buffer_load_dwordx4 v[16:19], v2, s[44:47], s71 offen sc0 sc1
  buffer_load_dwordx4 v[20:23], v2, s[44:47], s72 offen sc0 sc1
  s_waitcnt vmcnt(0)
  v_cmp_ne_u32 vcc, v19, v100
  v_cmp_ne_u32 s[76:77], v23, v100
  s_or_b64 s[76:77], vcc, s[76:77]
  s_cbranch_scc0 L_r1poll_done
  s_add_u32 s75, s75, 1
  s_cmp_lt_u32 s75, 262144
  s_cbranch_scc1 L_r1poll
L_r1poll_done:
  v_perm_b32 v52, v16, v17, s82
  v_perm_b32 v19, v52, v18, s83
  v_perm_b32 v52, v20, v21, s82
  v_perm_b32 v23, v52, v22, s83
  v_add_f32 v48, v16, v20
  v_add_f32 v49, v17, v21
  v_add_f32 v50, v18, v22
  v_add_f32 v51, v19, v23
  s_nop 1
  v_add_f32_dpp v48, v48, v48 row_ror:4 row_mask:0xf bank_mask:0xf
  v_add_f32_dpp v49, v49, v49 row_ror:4 row_mask:0xf bank_mask:0xf
  v_add_f32_dpp v50, v50, v50 row_ror:4 row_mask:0xf bank_mask:0xf
  v_add_f32_dpp v51, v51, v51 row_ror:4 row_mask:0xf bank_mask:0xf
  s_nop 1
  v_add_f32_dpp v48, v48, v48 row_ror:8 row_mask:0xf bank_mask:0xf
  v_add_f32_dpp v49, v49, v49 row_ror:8 row_mask:0xf bank_mask:0xf
  v_add_f32_dpp v50, v50, v50 row_ror:8 row_mask:0xf bank_mask:0xf
  v_add_f32_dpp v51, v51, v51 row_ror:8 row_mask:0xf bank_mask:0xf
  v_mov_b32 v52, v48
  v_mov_b32 v53, v49
  v_mov_b32 v54, v50
  v_mov_b32 v55, v51
  s_nop 1
  v_permlane16_swap_b32 v48, v52
  v_permlane16_swap_b32 v49, v53
  v_permlane16_swap_b32 v50, v54
  v_permlane16_swap_b32 v51, v55
  s_nop 1
  v_add_f32 v48, v48, v52
  v_add_f32 v49, v49, v53
  v_add_f32 v50, v50, v54
  v_add_f32 v51, v51, v55
  v_mov_b32 v52, v48
  v_mov_b32 v53, v49
  v_mov_b32 v54, v50
  v_mov_b32 v55, v51
  s_nop 1
  v_permlane32_swap_b32 v48, v52
  v_permlane32_swap_b32 v49, v53
  v_permlane32_swap_b32 v50, v54
  v_permlane32_swap_b32 v51, v55
  s_nop 1
  v_add_f32 v48, v48, v52
  v_add_f32 v49, v49, v53
  v_add_f32 v50, v50, v54
  v_add_f32 v51, v51, v55
  v_cvt_pk_bf16_f32 v48, 0, v48
  v_cvt_pk_bf16_f32 v49, 0, v49
  v_cvt_pk_bf16_f32 v50, 0, v50
  v_cvt_pk_bf16_f32 v51, 0, v51
  v_add_f32 v48, v48, v102
  v_add_f32 v49, v49, v103
  v_add_f32 v50, v50, v104
  v_add_f32 v51, v51, v105
  v_cvt_pk_bf16_f32 v8, v48, v49
  v_cvt_pk_bf16_f32 v9, v50, v51
  buffer_store_dwordx4 v[8:11], v2, s[44:47], s80 offen sc0 sc1
  v_mov_b32 v7, 262144
  v_cmp_gt_u32 s[50:51], 11, v5
  s_nop 1
  v_cndmask_b32 v7, 0, v7, s[50:51]
  v_add_u32 v7, v7, v2
  s_lshl_b32 s71, s68, 6
  s_add_u32 s71, s71, 524288
  s_add_u32 s72, s71, 131072
  v_lshlrev_b32 v56, 16, v8
  v_and_b32 v57, 0xffff0000, v8
  v_lshlrev_b32 v58, 16, v9
  v_and_b32 v59, 0xffff0000, v9
  v_lshlrev_b32 v4, 1, v6
  s_lshl_b32 s74, s68, 3
  s_mov_b32 s75, 0
L_r2poll:
  buffer_load_dwordx4 v[16:19], v2, s[44:47], s71 offen sc0 sc1
  buffer_load_dwordx4 v[20:23], v2, s[44:47], s72 offen sc0 sc1
  buffer_load_dwordx4 v[24:27], v7, s[44:47], s71 offen sc0 sc1
  s_waitcnt vmcnt(0)
  v_cmp_ne_u32 vcc, v19, v100
  v_cmp_ne_u32 s[76:77], v23, v100
  s_or_b64 vcc, vcc, s[76:77]
  v_cmp_ne_u32 s[76:77], v27, v100
  s_or_b64 s[76:77], vcc, s[76:77]
  s_cbranch_scc0 L_r2poll_done
  s_add_u32 s75, s75, 1
  s_cmp_lt_u32 s75, 262144
  s_cbranch_scc1 L_r2poll
L_r2poll_done:
  v_cndmask_b32 v24, 0, v24, s[50:51]
  v_cndmask_b32 v25, 0, v25, s[50:51]
  v_cndmask_b32 v26, 0, v26, s[50:51]
  v_perm_b32 v52, v16, v17, s82
  v_perm_b32 v19, v52, v18, s83
  v_perm_b32 v52, v20, v21, s82
  v_perm_b32 v23, v52, v22, s83
  v_perm_b32 v52, v24, v25, s82
  v_perm_b32 v27, v52, v26, s83
  v_add_f32 v48, v16, v20
  v_add_f32 v49, v17, v21
  v_add_f32 v50, v18, v22
  v_add_f32 v51, v19, v23
  v_add_f32 v48, v48, v24
  v_add_f32 v49, v49, v25
  v_add_f32 v50, v50, v26
  v_add_f32 v51, v51, v27
  s_nop 1
  v_add_f32_dpp v48, v48, v48 row_ror:4 row_mask:0xf bank_mask:0xf
  v_add_f32_dpp v49, v49, v49 row_ror:4 row_mask:0xf bank_mask:0xf
  v_add_f32_dpp v50, v50, v50 row_ror:4 row_mask:0xf bank_mask:0xf
  v_add_f32_dpp v51, v51, v51 row_ror:4 row_mask:0xf bank_mask:0xf
  s_nop 1
  v_add_f32_dpp v48, v48, v48 row_ror:8 row_mask:0xf bank_mask:0xf
  v_add_f32_dpp v49, v49, v49 row_ror:8 row_mask:0xf bank_mask:0xf
  v_add_f32_dpp v50, v50, v50 row_ror:8 row_mask:0xf bank_mask:0xf
  v_add_f32_dpp v51, v51, v51 row_ror:8 row_mask:0xf bank_mask:0xf
  v_mov_b32 v52, v48
  v_mov_b32 v53, v49
  v_mov_b32 v54, v50
  v_mov_b32 v55, v51
  s_nop 1
  v_permlane16_swap_b32 v48, v52
  v_permlane16_swap_b32 v49, v53
  v_permlane16_swap_b32 v50, v54
  v_permlane16_swap_b32 v51, v55
  s_nop 1
  v_add_f32 v48, v48, v52
  v_add_f32 v49, v49, v53
  v_add_f32 v50, v50, v54
  v_add_f32 v51, v51, v55
  v_mov_b32 v52, v48
  v_mov_b32 v53, v49
  v_mov_b32 v54, v50
  v_mov_b32 v55, v51
  s_nop 1
  v_permlane32_swap_b32 v48, v52
  v_permlane32_swap_b32 v49, v53
  v_permlane32_swap_b32 v50, v54
  v_permlane32_swap_b32 v51, v55
  s_nop 1
  v_add_f32 v48, v48, v52
  v_add_f32 v49, v49, v53
  v_add_f32 v50, v50, v54
  v_add_f32 v51, v51, v55
  v_cvt_pk_bf16_f32 v48, 0, v48
  v_cvt_pk_bf16_f32 v49, 0, v49
  v_cvt_pk_bf16_f32 v50, 0, v50
  v_cvt_pk_bf16_f32 v51, 0, v51
  v_add_f32 v48, v48, v56
  v_add_f32 v49, v49, v57
  v_add_f32 v50, v50, v58
  v_add_f32 v51, v51, v59
  v_cvt_pk_bf16_f32 v48, 0, v48
  v_cvt_pk_bf16_f32 v49, 0, v49
  v_cvt_pk_bf16_f32 v50, 0, v50
  v_cvt_pk_bf16_f32 v51, 0, v51
  s_mov_b64 exec, 15
  buffer_store_short_d16_hi v48, v4, s[52:55], s74 offen offset:0 sc0 sc1
  buffer_store_short_d16_hi v49, v4, s[52:55], s74 offen offset:1024 sc0 sc1
  buffer_store_short_d16_hi v50, v4, s[52:55], s74 offen offset:2048 sc0 sc1
  buffer_store_short_d16_hi v51, v4, s[52:55], s74 offen offset:3072 sc0 sc1
  s_cmp_lg_u32 s68, 0
  s_cbranch_scc1 L_nogen
  s_mov_b32 s71, 1044480
  s_mov_b64 exec, 1
  v_mov_b32 v4, 0
  buffer_store_dword v100, v4, s[44:47], s71 offen sc0 sc1
L_nogen:
  s_mov_b64 exec, -1
  s_branch L_fin
L_ffn:
  v_lshrrev_b32 v3, 4, v0
  v_lshlrev_b32 v3, 10, v3
  v_and_b32 v8, 15, v0
  v_lshlrev_b32 v8, 4, v8
  v_add_u32 v3, v3, v8
  s_lshl_b32 s80, s66, 15
  s_lshl_b32 s81, s3, 8
  s_add_u32 s80, s80, s81
  s_lshl_b32 s81, s3, 13
  s_add_u32 s83, s81, 114688
  s_add_u32 m0, s83, 0
  s_add_u32 s79, s80, 0
  buffer_load_dwordx4 v3, s[40:43], s79 offen nt lds
  s_add_u32 m0, s83, 1024
  s_add_u32 s79, s80, 4096
  buffer_load_dwordx4 v3, s[40:43], s79 offen nt lds
  s_add_u32 m0, s83, 2048
  s_add_u32 s79, s80, 8192
  buffer_load_dwordx4 v3, s[40:43], s79 offen nt lds
  s_add_u32 m0, s83, 3072
  s_add_u32 s79, s80, 12288
  buffer_load_dwordx4 v3, s[40:43], s79 offen nt lds
  s_add_u32 m0, s83, 4096
  s_add_u32 s79, s80, 16384
  buffer_load_dwordx4 v3, s[40:43], s79 offen nt lds
  s_add_u32 m0, s83, 5120
  s_add_u32 s79, s80, 20480
  buffer_load_dwordx4 v3, s[40:43], s79 offen nt lds
  s_add_u32 m0, s83, 6144
  s_add_u32 s79, s80, 24576
  buffer_load_dwordx4 v3, s[40:43], s79 offen nt lds
  s_add_u32 m0, s83, 7168
  s_add_u32 s79, s80, 28672
  buffer_load_dwordx4 v3, s[40:43], s79 offen nt lds
  v_lshrrev_b32 v11, 4, v0
  v_lshlrev_b32 v11, 3, v11
  v_lshrrev_b32 v12, 2, v0
  v_and_b32 v12, 3, v12
  v_add_u32 v11, v11, v12
  v_and_b32 v12, 3, v0
  v_lshlrev_b32 v12, 3, v12
  s_lshl_b32 s69, s3, 13
  s_add_u32 s72, s69, 49152
  s_add_u32 s73, s69, 114688
  v_lshlrev_b32 v16, 6, v11
  v_add_u32 v16, v16, v12
  v_add_u32 v16, s72, v16
  v_add_u32 v17, 0x8000, v16
  v_lshlrev_b32 v18, 8, v11
  v_add_u32 v18, v18, v12
  v_add_u32 v18, s73, v18
  v_lshlrev_b32 v2, 5, v0
  s_lshl_b32 s68, s3, 11
  s_and_b32 s69, s66, 15
  s_lshl_b32 s69, s69, 13
  s_add_u32 s68, s68, s69
  s_add_u32 s68, s68, 884736
  v_lshlrev_b32 v3, 4, v0
  s_mul_i32 s69, s3, 1040
  v_add_u32 v3, s69, v3
  v_and_b32 v4, 3, v0
  v_mul_u32_u24 v4, 1040, v4
  v_lshrrev_b32 v5, 4, v0
  v_lshlrev_b32 v5, 4, v5
  v_add_u32 v4, v4, v5
  s_lshl_b32 s69, s3, 8
  v_add_u32 v4, s69, v4
  v_lshlrev_b32 v6, 2, v0
  v_add_u32 v6, s69, v6
  s_mov_b32 s78, 0x07060302
  s_mov_b32 s79, 0x05040100
  ds_read_b64_tr_b16 a[0:1], v16 offset:0
  ds_read_b64_tr_b16 a[2:3], v16 offset:256
  ds_read_b64_tr_b16 a[4:5], v16 offset:32
  ds_read_b64_tr_b16 a[6:7], v16 offset:288
  ds_read_b64_tr_b16 a[8:9], v17 offset:0
  ds_read_b64_tr_b16 a[10:11], v17 offset:256
  ds_read_b64_tr_b16 a[12:13], v17 offset:32
  ds_read_b64_tr_b16 a[14:15], v17 offset:288
  s_waitcnt lgkmcnt(0)
  ds_read_b64_tr_b16 a[16:17], v16 offset:2048
  ds_read_b64_tr_b16 a[18:19], v16 offset:2304
  ds_read_b64_tr_b16 a[20:21], v16 offset:2080
  ds_read_b64_tr_b16 a[22:23], v16 offset:2336
  ds_read_b64_tr_b16 a[24:25], v17 offset:2048
  ds_read_b64_tr_b16 a[26:27], v17 offset:2304
  ds_read_b64_tr_b16 a[28:29], v17 offset:2080
  ds_read_b64_tr_b16 a[30:31], v17 offset:2336
  s_waitcnt lgkmcnt(0)
  ds_read_b64_tr_b16 a[32:33], v16 offset:4096
  ds_read_b64_tr_b16 a[34:35], v16 offset:4352
  ds_read_b64_tr_b16 a[36:37], v16 offset:4128
  ds_read_b64_tr_b16 a[38:39], v16 offset:4384
  ds_read_b64_tr_b16 a[40:41], v17 offset:4096
  ds_read_b64_tr_b16 a[42:43], v17 offset:4352
  ds_read_b64_tr_b16 a[44:45], v17 offset:4128
  ds_read_b64_tr_b16 a[46:47], v17 offset:4384
  s_waitcnt lgkmcnt(0)
  ds_read_b64_tr_b16 a[48:49], v16 offset:6144
  ds_read_b64_tr_b16 a[50:51], v16 offset:6400
  ds_read_b64_tr_b16 a[52:53], v16 offset:6176
  ds_read_b64_tr_b16 a[54:55], v16 offset:6432
  ds_read_b64_tr_b16 a[56:57], v17 offset:6144
  ds_read_b64_tr_b16 a[58:59], v17 offset:6400
  ds_read_b64_tr_b16 a[60:61], v17 offset:6176
  ds_read_b64_tr_b16 a[62:63], v17 offset:6432
  s_waitcnt lgkmcnt(0)
  s_mov_b32 s75, 0
  buffer_load_dwordx4 v[40:43], v2, s[44:47], s68 offen sc0 sc1
  buffer_load_dwordx4 v[44:47], v2, s[44:47], s68 offen offset:16 sc0 sc1
  s_waitcnt vmcnt(0)
  ds_read_b64_tr_b16 a[64:65], v18 offset:0
  ds_read_b64_tr_b16 a[66:67], v18 offset:1024
  ds_read_b64_tr_b16 a[68:69], v18 offset:32
  ds_read_b64_tr_b16 a[70:71], v18 offset:1056
  ds_read_b64_tr_b16 a[72:73], v18 offset:64
  ds_read_b64_tr_b16 a[74:75], v18 offset:1088
  ds_read_b64_tr_b16 a[76:77], v18 offset:96
  ds_read_b64_tr_b16 a[78:79], v18 offset:1120
  s_waitcnt lgkmcnt(4)
  ds_read_b64_tr_b16 a[80:81], v18 offset:128
  ds_read_b64_tr_b16 a[82:83], v18 offset:1152
  ds_read_b64_tr_b16 a[84:85], v18 offset:160
  ds_read_b64_tr_b16 a[86:87], v18 offset:1184
  ds_read_b64_tr_b16 a[88:89], v18 offset:192
  ds_read_b64_tr_b16 a[90:91], v18 offset:1216
  ds_read_b64_tr_b16 a[92:93], v18 offset:224
  ds_read_b64_tr_b16 a[94:95], v18 offset:1248
  s_branch L_hpoll_w
L_hpoll:
  buffer_load_dwordx4 v[40:43], v2, s[44:47], s68 offen sc0 sc1
  buffer_load_dwordx4 v[44:47], v2, s[44:47], s68 offen offset:16 sc0 sc1
L_hpoll_w:
  s_waitcnt vmcnt(0)
  v_cmp_ne_u64 vcc, v[42:43], v[100:101]
  v_cmp_ne_u64 s[76:77], v[46:47], v[100:101]
  s_or_b64 s[76:77], vcc, s[76:77]
  s_cbranch_scc0 L_hpoll_done
  s_add_u32 s75, s75, 1
  s_cmp_lt_u32 s75, 262144
  s_cbranch_scc1 L_hpoll
L_hpoll_done:
  v_perm_b32 v36, v44, v40, s79
  v_perm_b32 v37, v44, v40, s78
  v_perm_b32 v38, v45, v41, s79
  v_perm_b32 v39, v45, v41, s78
  ds_write_b32 v6, v36 offset:5248
  ds_write_b32 v6, v37 offset:6288
  ds_write_b32 v6, v38 offset:7328
  ds_write_b32 v6, v39 offset:8368
  s_waitcnt lgkmcnt(0)
  s_barrier
  ds_read_b128 v[36:39], v3 offset:5248
  s_mov_b32 s77, 0x07060302
  s_waitcnt lgkmcnt(0)
  v_lshlrev_b32 v24, 16, v36
  v_and_b32 v25, 0xffff0000, v36
  v_lshlrev_b32 v26, 16, v37
  v_and_b32 v27, 0xffff0000, v37
  v_lshlrev_b32 v28, 16, v38
  v_and_b32 v29, 0xffff0000, v38
  v_lshlrev_b32 v30, 16, v39
  v_and_b32 v31, 0xffff0000, v39
  v_add_f32 v32, v24, v25
  v_add_f32 v33, v26, v27
  v_add_f32 v34, v28, v29
  v_add_f32 v35, v30, v31
  v_add_f32 v32, v32, v33
  v_add_f32 v34, v34, v35
  v_add_f32 v32, v32, v34
  s_nop 1
  v_add_f32_dpp v32, v32, v32 row_ror:8 row_mask:0xf bank_mask:0xf
  s_nop 1
  v_add_f32_dpp v32, v32, v32 row_ror:4 row_mask:0xf bank_mask:0xf
  s_nop 1
  v_add_f32_dpp v32, v32, v32 row_ror:2 row_mask:0xf bank_mask:0xf
  s_nop 1
  v_add_f32_dpp v32, v32, v32 row_ror:1 row_mask:0xf bank_mask:0xf
  s_nop 1
  v_add_f32_dpp v32, v32, v32 row_bcast:15 row_mask:0xa bank_mask:0xf
  s_nop 1
  v_add_f32_dpp v32, v32, v32 row_bcast:31 row_mask:0xc bank_mask:0xf
  v_mov_b32 v33, 0x3b000000
  v_readlane_b32 s69, v32, 63
  s_nop 1
  v_mul_f32 v33, s69, v33
  v_sub_f32 v34, v24, v33
  v_mul_f32 v32, v34, v34
  v_sub_f32 v34, v25, v33
  v_fmac_f32 v32, v34, v34
  v_sub_f32 v34, v26, v33
  v_fmac_f32 v32, v34, v34
  v_sub_f32 v34, v27, v33
  v_fmac_f32 v32, v34, v34
  v_sub_f32 v34, v28, v33
  v_fmac_f32 v32, v34, v34
  v_sub_f32 v34, v29, v33
  v_fmac_f32 v32, v34, v34
  v_sub_f32 v34, v30, v33
  v_fmac_f32 v32, v34, v34
  v_sub_f32 v34, v31, v33
  v_fmac_f32 v32, v34, v34
  v_cvt_pk_bf16_f32 v33, 0, v33
  v_sub_f32 v24, v24, v33
  v_sub_f32 v25, v25, v33
  v_add_f32_dpp v32, v32, v32 row_ror:8 row_mask:0xf bank_mask:0xf
  v_sub_f32 v26, v26, v33
  v_sub_f32 v27, v27, v33
  v_add_f32_dpp v32, v32, v32 row_ror:4 row_mask:0xf bank_mask:0xf
  v_sub_f32 v28, v28, v33
  v_sub_f32 v29, v29, v33
  v_add_f32_dpp v32, v32, v32 row_ror:2 row_mask:0xf bank_mask:0xf
  v_sub_f32 v30, v30, v33
  v_sub_f32 v31, v31, v33
  v_add_f32_dpp v32, v32, v32 row_ror:1 row_mask:0xf bank_mask:0xf
  v_cvt_pk_bf16_f32 v24, 0, v24
  v_cvt_pk_bf16_f32 v25, 0, v25
  v_add_f32_dpp v32, v32, v32 row_bcast:15 row_mask:0xa bank_mask:0xf
  v_cvt_pk_bf16_f32 v26, 0, v26
  v_cvt_pk_bf16_f32 v27, 0, v27
  v_add_f32_dpp v32, v32, v32 row_bcast:31 row_mask:0xc bank_mask:0xf
  v_cvt_pk_bf16_f32 v28, 0, v28
  v_mov_b32 v34, 0x3b000000
  v_readlane_b32 s69, v32, 63
  v_cvt_pk_bf16_f32 v29, 0, v29
  v_cvt_pk_bf16_f32 v30, 0, v30
  v_cvt_pk_bf16_f32 v31, 0, v31
  v_mul_f32 v34, s69, v34
  v_cvt_pk_bf16_f32 v34, 0, v34
  v_add_f32 v34, 0x3727c5ac, v34
  v_cvt_pk_bf16_f32 v34, 0, v34
  v_sqrt_f32 v34, v34
  s_nop 0
  v_cvt_pk_bf16_f32 v34, 0, v34
  v_rcp_f32 v35, v34
  s_nop 0
  v_mul_f32 v32, v24, v35
  v_fma_f32 v24, -v32, v34, v24
  v_fma_f32 v24, v24, v35, v32
  v_cvt_pk_bf16_f32 v24, 0, v24
  v_mul_f32 v32, v25, v35
  v_fma_f32 v25, -v32, v34, v25
  v_fma_f32 v25, v25, v35, v32
  v_cvt_pk_bf16_f32 v25, 0, v25
  v_mul_f32 v32, v26, v35
  v_fma_f32 v26, -v32, v34, v26
  v_fma_f32 v26, v26, v35, v32
  v_cvt_pk_bf16_f32 v26, 0, v26
  v_mul_f32 v32, v27, v35
  v_fma_f32 v27, -v32, v34, v27
  v_fma_f32 v27, v27, v35, v32
  v_cvt_pk_bf16_f32 v27, 0, v27
  v_mul_f32 v32, v28, v35
  v_fma_f32 v28, -v32, v34, v28
  v_fma_f32 v28, v28, v35, v32
  v_cvt_pk_bf16_f32 v28, 0, v28
  v_mul_f32 v32, v29, v35
  v_fma_f32 v29, -v32, v34, v29
  v_fma_f32 v29, v29, v35, v32
  v_cvt_pk_bf16_f32 v29, 0, v29
  v_mul_f32 v32, v30, v35
  v_fma_f32 v30, -v32, v34, v30
  v_fma_f32 v30, v30, v35, v32
  v_cvt_pk_bf16_f32 v30, 0, v30
  v_mul_f32 v32, v31, v35
  v_fma_f32 v31, -v32, v34, v31
  v_fma_f32 v31, v31, v35, v32
  v_cvt_pk_bf16_f32 v31, 0, v31
  v_perm_b32 v36, v25, v24, s77
  v_perm_b32 v37, v27, v26, s77
  v_perm_b32 v38, v29, v28, s77
  v_perm_b32 v39, v31, v30, s77
  ds_write_b128 v3, v[36:39] offset:5248
  s_waitcnt lgkmcnt(0)
  s_barrier
  ds_read_b128 v[24:27], v4 offset:5248
  ds_read_b128 v[28:31], v4 offset:5312
  ds_read_b128 v[32:35], v4 offset:5376
  ds_read_b128 v[36:39], v4 offset:5440
  v_lshlrev_b32 v2, 4, v0
  s_lshl_b32 s68, s3, 10
  v_add_u32 v3, s68, v2
  s_waitcnt lgkmcnt(3)
  v_mfma_f32_16x16x32_bf16 v[64:67], v[24:27], a[0:3], 0
  v_mfma_f32_16x16x32_bf16 v[68:71], v[24:27], a[4:7], 0
  v_mfma_f32_16x16x32_bf16 v[72:75], v[24:27], a[8:11], 0
  v_mfma_f32_16x16x32_bf16 v[76:79], v[24:27], a[12:15], 0
  s_waitcnt lgkmcnt(2)
  v_mfma_f32_16x16x32_bf16 v[64:67], v[28:31], a[16:19], v[64:67]
  v_mfma_f32_16x16x32_bf16 v[68:71], v[28:31], a[20:23], v[68:71]
  v_mfma_f32_16x16x32_bf16 v[72:75], v[28:31], a[24:27], v[72:75]
  v_mfma_f32_16x16x32_bf16 v[76:79], v[28:31], a[28:31], v[76:79]
  s_waitcnt lgkmcnt(1)
  v_mfma_f32_16x16x32_bf16 v[64:67], v[32:35], a[32:35], v[64:67]
  v_mfma_f32_16x16x32_bf16 v[68:71], v[32:35], a[36:39], v[68:71]
  v_mfma_f32_16x16x32_bf16 v[72:75], v[32:35], a[40:43], v[72:75]
  v_mfma_f32_16x16x32_bf16 v[76:79], v[32:35], a[44:47], v[76:79]
  s_waitcnt lgkmcnt(0)
  v_mfma_f32_16x16x32_bf16 v[64:67], v[36:39], a[48:51], v[64:67]
  v_mfma_f32_16x16x32_bf16 v[68:71], v[36:39], a[52:55], v[68:71]
  v_mfma_f32_16x16x32_bf16 v[72:75], v[36:39], a[56:59], v[72:75]
  v_mfma_f32_16x16x32_bf16 v[76:79], v[36:39], a[60:63], v[76:79]
  s_mov_b64 exec, 0xffff
  s_nop 4
  ds_write_b128 v3, v[64:67] offset:9408
  ds_write_b128 v3, v[68:71] offset:9664
  ds_write_b128 v3, v[72:75] offset:9920
  ds_write_b128 v3, v[76:79] offset:10176
  s_mov_b64 exec, -1
  s_waitcnt lgkmcnt(0)
  s_barrier
  ds_read_b128 v[24:27], v2 offset:9408
  ds_read_b128 v[28:31], v2 offset:10432
  ds_read_b128 v[32:35], v2 offset:11456
  ds_read_b128 v[36:39], v2 offset:12480
  v_lshrrev_b32 v4, 5, v0
  v_mul_u32_u24 v4, 160, v4
  v_and_b32 v5, 31, v0
  v_lshlrev_b32 v5, 1, v5
  v_add_u32 v4, v4, v5
  s_mul_i32 s68, s3, 320
  v_add_u32 v4, s68, v4
  v_and_b32 v5, 3, v0
  v_mul_u32_u24 v5, 80, v5
  v_lshrrev_b32 v6, 4, v0
  v_lshlrev_b32 v6, 4, v6
  v_add_u32 v5, v5, v6
  v_add_u32 v5, s68, v5
  v_mov_b32 v40, 0x3d372713
  s_waitcnt lgkmcnt(0)
  v_add_f32 v24, v24, v28
  v_add_f32 v32, v32, v36
  v_add_f32 v25, v25, v29
  v_add_f32 v33, v33, v37
  v_add_f32 v26, v26, v30
  v_add_f32 v34, v34, v38
  v_add_f32 v27, v27, v31
  v_add_f32 v35, v35, v39
  v_add_f32 v24, v24, v32
  v_add_f32 v25, v25, v33
  v_add_f32 v26, v26, v34
  v_add_f32 v27, v27, v35
  s_nop 1
  v_permlane32_swap_b32 v24, v26
  v_permlane32_swap_b32 v25, v27
  s_nop 1
  v_cvt_pk_bf16_f32 v24, 0, v24
  v_cvt_pk_bf16_f32 v25, 0, v25
  v_cvt_pk_bf16_f32 v26, 0, v26
  v_cvt_pk_bf16_f32 v27, 0, v27
  v_mul_f32 v28, v24, v24
  v_mul_f32 v32, v25, v25
  v_mul_f32 v28, v28, v24
  v_mul_f32 v32, v32, v25
  v_fma_f32 v28, v28, v40, v24
  v_fma_f32 v32, v32, v40, v25
  v_mul_f32 v28, 0xc0135761, v28
  v_mul_f32 v32, 0xc0135761, v32
  v_exp_f32 v28, v28
  v_exp_f32 v32, v32
  s_nop 0
  v_add_f32 v28, 1.0, v28
  v_add_f32 v32, 1.0, v32
  v_rcp_f32 v28, v28
  v_rcp_f32 v32, v32
  s_nop 0
  v_mul_f32 v28, v28, v24
  v_mul_f32 v32, v32, v25
  v_cvt_pk_bf16_f32 v28, 0, v28
  v_cvt_pk_bf16_f32 v32, 0, v32
  v_mul_f32 v28, v28, v26
  v_mul_f32 v32, v32, v27
  v_cvt_pk_bf16_f32 v28, 0, v28
  v_cvt_pk_bf16_f32 v32, 0, v32
  ds_write_b16_d16_hi v4, v28 offset:13504
  ds_write_b16_d16_hi v4, v32 offset:13584
  s_lshl_b32 s68, s66, 13
  s_lshl_b32 s69, s3, 11
  s_add_u32 s68, s68, s69
  s_add_u32 s68, s68, 524288
  s_waitcnt lgkmcnt(0)
  ds_read_b128 v[24:27], v5 offset:13504
  s_waitcnt lgkmcnt(0)
  v_mfma_f32_16x16x32_bf16 v[64:67], v[24:27], a[64:67], 0
  v_mfma_f32_16x16x32_bf16 v[68:71], v[24:27], a[68:71], 0
  v_mfma_f32_16x16x32_bf16 v[72:75], v[24:27], a[72:75], 0
  v_mfma_f32_16x16x32_bf16 v[76:79], v[24:27], a[76:79], 0
  v_mfma_f32_16x16x32_bf16 v[80:83], v[24:27], a[80:83], 0
  v_mfma_f32_16x16x32_bf16 v[84:87], v[24:27], a[84:87], 0
  v_mfma_f32_16x16x32_bf16 v[88:91], v[24:27], a[88:91], 0
  v_mfma_f32_16x16x32_bf16 v[92:95], v[24:27], a[92:95], 0
  s_mov_b64 exec, 0xffff
  s_nop 3
  v_perm_b32 v64, v64, v67, s61
  v_perm_b32 v65, v65, v67, s62
  v_perm_b32 v66, v66, v67, s63
  v_mov_b32 v67, v100
  buffer_store_dwordx4 v[64:67], v2, s[44:47], s68 offen offset:0 sc0 sc1
  v_perm_b32 v68, v68, v71, s61
  v_perm_b32 v69, v69, v71, s62
  v_perm_b32 v70, v70, v71, s63
  v_mov_b32 v71, v100
  buffer_store_dwordx4 v[68:71], v2, s[44:47], s68 offen offset:256 sc0 sc1
  v_perm_b32 v72, v72, v75, s61
  v_perm_b32 v73, v73, v75, s62
  v_perm_b32 v74, v74, v75, s63
  v_mov_b32 v75, v100
  buffer_store_dwordx4 v[72:75], v2, s[44:47], s68 offen offset:512 sc0 sc1
  v_perm_b32 v76, v76, v79, s61
  v_perm_b32 v77, v77, v79, s62
  v_perm_b32 v78, v78, v79, s63
  v_mov_b32 v79, v100
  buffer_store_dwordx4 v[76:79], v2, s[44:47], s68 offen offset:768 sc0 sc1
  v_perm_b32 v80, v80, v83, s61
  v_perm_b32 v81, v81, v83, s62
  v_perm_b32 v82, v82, v83, s63
  v_mov_b32 v83, v100
  buffer_store_dwordx4 v[80:83], v2, s[44:47], s68 offen offset:1024 sc0 sc1
  v_perm_b32 v84, v84, v87, s61
  v_perm_b32 v85, v85, v87, s62
  v_perm_b32 v86, v86, v87, s63
  v_mov_b32 v87, v100
  buffer_store_dwordx4 v[84:87], v2, s[44:47], s68 offen offset:1280 sc0 sc1
  v_perm_b32 v88, v88, v91, s61
  v_perm_b32 v89, v89, v91, s62
  v_perm_b32 v90, v90, v91, s63
  v_mov_b32 v91, v100
  buffer_store_dwordx4 v[88:91], v2, s[44:47], s68 offen offset:1536 sc0 sc1
  v_perm_b32 v92, v92, v95, s61
  v_perm_b32 v93, v93, v95, s62
  v_perm_b32 v94, v94, v95, s63
  v_mov_b32 v95, v100
  buffer_store_dwordx4 v[92:95], v2, s[44:47], s68 offen offset:1792 sc0 sc1
  s_mov_b64 exec, -1
L_fin:
  s_endpgm
L_exit:
  s_endpgm
L_codeend:
  s_endpgm
.section .rodata,"a"
.p2align 6
.amdhsa_kernel sequential_preLN__gqa_block_cached__geglu_ffn__decode_kernel
  .amdhsa_next_free_vgpr 256
  .amdhsa_next_free_sgpr 102
  .amdhsa_accum_offset 128
  .amdhsa_group_segment_fixed_size 0
  .amdhsa_kernarg_size 96
  .amdhsa_user_sgpr_count 2
  .amdhsa_user_sgpr_kernarg_segment_ptr 1
  .amdhsa_system_sgpr_workgroup_id_x 1
.end_amdhsa_kernel
```
